```python
import torch

def _softmax(x, axis=-1):
    return torch.softmax(x, dim=axis)
def _gelu(x):
    return torch.nn.functional.gelu(x, approximate="tanh")
def _silu(x):
    return torch.nn.functional.silu(x)
def _sigmoid(x):
    return torch.sigmoid(x)
def _layernorm(x, axis=-1, eps=1e-5):
    m = x.mean(dim=axis, keepdim=True)
    v = x.var(dim=axis, keepdim=True, unbiased=False)
    return (x - m) / torch.sqrt(v + eps)
def _scatter_add(tgt, idx, src, axis=0):
    return tgt.clone().index_add_(axis, idx, src)
def _segment_sum(src, seg, n):
    out = torch.zeros((n,) + src.shape[1:], dtype=src.dtype)
    return out.index_add_(0, seg, src)
def _pad(x, pw):
    flat = tuple(v for pair in reversed(pw) for v in pair)
    return torch.nn.functional.pad(x, flat)

kernel_name = 'gated_mix__ssm_conv_s4__swiglu_ffn__prompt'

def setup_inputs():

    _w = (lambda a: (lambda t: t.to(torch.bfloat16) if t.is_floating_point() else t)(torch.as_tensor(a)))
    def _A_setup():
        B, L, D, N = 1, 2048, 448, 256
        A_re = -(lambda _x: torch.exp(torch.as_tensor(_x)))((lambda *s: torch.randn(*s, dtype=torch.bfloat16) * 3.2)(D, N))
        A_im = torch.pi * (lambda *s: torch.randn(*s, dtype=torch.bfloat16) * 0.05)(D, N)
        B_re = (lambda *s: torch.randn(*s, dtype=torch.bfloat16) * 0.05)(D, N)
        B_im = (lambda *s: torch.randn(*s, dtype=torch.bfloat16) * 0.05)(D, N)
        C_re = (lambda *s: torch.randn(*s, dtype=torch.bfloat16) * 0.1)(D, N)
        C_im = (lambda *s: torch.randn(*s, dtype=torch.bfloat16) * 0.1)(D, N)
        log_dt = (lambda *s: torch.randn(*s, dtype=torch.bfloat16) * 0.05)(D) * 0.5 - 4.0
        Dskip = (lambda *s: torch.randn(*s, dtype=torch.bfloat16) * 0.05)(D)
        return {
            "u": _w((lambda *s: torch.randn(*s, dtype=torch.bfloat16) * 0.05)(B, L, D)),
            "A_re": _w(A_re),
            "A_im": _w(A_im),
            "B_re": _w(B_re),
            "B_im": _w(B_im),
            "C_re": _w(C_re),
            "C_im": _w(C_im),
            "log_dt": _w(log_dt),
            "Dskip": _w(Dskip),
        }
    _A_in = _A_setup()

    def _B_setup():
        B, S, D, F = 1, 2048, 448, 1792
        return {
            "x": _w((lambda *s: torch.randn(*s, dtype=torch.bfloat16) * 0.05)(B, S, D)),
            "w_gate": _w((lambda *s: torch.randn(*s, dtype=torch.bfloat16) * 0.05)(D, F)),
            "w_up": _w((lambda *s: torch.randn(*s, dtype=torch.bfloat16) * 0.05)(D, F)),
            "w_down": _w((lambda *s: torch.randn(*s, dtype=torch.bfloat16) * 0.05)(F, D)),
        }
    _B_in = _B_setup()

    return {
        "A_u": _A_in["u"],
        "A_A_re": _A_in["A_re"],
        "A_A_im": _A_in["A_im"],
        "A_B_re": _A_in["B_re"],
        "A_B_im": _A_in["B_im"],
        "A_C_re": _A_in["C_re"],
        "A_C_im": _A_in["C_im"],
        "A_log_dt": _A_in["log_dt"],
        "A_Dskip": _A_in["Dskip"],
        "B_x": _B_in["x"],
        "B_w_gate": _B_in["w_gate"],
        "B_w_up": _B_in["w_up"],
        "B_w_down": _B_in["w_down"],
        "gate_w": _w((lambda *s: torch.randn(*s, dtype=torch.bfloat16) * 0.05)(448) * 16.0),
    }

def reference(A_u, A_A_re, A_A_im, A_B_re, A_B_im, A_C_re, A_C_im, A_log_dt, A_Dskip, B_x, B_w_gate, B_w_up, B_w_down, gate_w):
    def _A_ref(u, A_re, A_im, B_re, B_im, C_re, C_im, log_dt, Dskip):
        Bsz, L, D = u.shape
        dt = torch.exp(log_dt)[:, None]
        A = A_re + 1j * A_im
        Bc = B_re + 1j * B_im
        Cc = C_re + 1j * C_im
        logdA = dt * A
        dB = dt * Bc
        l = (lambda x, dt: x.to(dt))(torch.arange(L), A_re.dtype)
        P = torch.exp(logdA[:, :, None] * l[None, None, :])
        K = torch.einsum("dn,dnl,dn->dl", Cc, P, dB).real
        L2 = 2 * L
        Kp = _pad(K, ((0, 0), (0, L)))
        up = (lambda x, *d: x.permute(*d))(u, 0, 2, 1)
        up = _pad(up, ((0, 0), (0, 0), (0, L)))
        Kf = (lambda x, axes=(-2,-1): torch.fft.rfft2(x.float(), dim=axes))(Kp[:, None, :], axes=(-2, -1))
        Uf = (lambda x, axes=(-2,-1): torch.fft.rfft2(x.float(), dim=axes))(up[:, :, None, :], axes=(-2, -1))
        Yf = Uf * Kf[None, :, :, :]
        y = (lambda x, s, axes=(-2,-1): torch.fft.irfft2(x, s=s, dim=axes).to(torch.bfloat16))(Yf, (1, L2), axes=(-2, -1))[:, :, 0, :L]
        y = (lambda x, *d: x.permute(*d))(y, 0, 2, 1) + u * Dskip[None, None, :]
        return y

    def _B_ref(x, w_gate, w_up, w_down):
        g = _silu(x @ w_gate)
        u = x @ w_up
        return (g * u) @ w_down

    x = A_u
    g = _sigmoid((x * gate_w).sum(-1, keepdims=True))
    a = _A_ref(x, A_A_re, A_A_im, A_B_re, A_B_im, A_C_re, A_C_im, A_log_dt, A_Dskip)
    b = _B_ref(x, B_w_gate, B_w_up, B_w_down)
    return g * a + (1 - g) * b
```

```asm
; @launch grid=(256,1,1) block=(512,1,1) lds=163840
.amdgcn_target "amdgcn-amd-amdhsa--gfx950"
.text
.globl gated_mix__ssm_conv_s4__swiglu_ffn__prompt_kernel
.p2align 8
.type gated_mix__ssm_conv_s4__swiglu_ffn__prompt_kernel,@function
gated_mix__ssm_conv_s4__swiglu_ffn__prompt_kernel:
    s_cmp_ge_u32 s2, 256
    s_cbranch_scc1 k_end
    s_add_u32 s2, s2, 224
    s_and_b32 s2, s2, 255
    s_load_dwordx16 s[16:31], s[0:1], 0
    s_load_dwordx8 s[32:39], s[0:1], 80
    s_load_dwordx2 s[40:41], s[0:1], 128
    s_load_dwordx4 s[96:99], s[0:1], 112
    s_getpc_b64 s[4:5]
k_pc:
    v_lshrrev_b32 v2, 6, v0
    v_and_b32 v1, 63, v0
    v_readfirstlane_b32 s3, v2
    s_lshr_b32 s6, s2, 3
    s_and_b32 s8, s6, 3
    s_mul_i32 s7, s8, 6144
    v_min_u32 v3, 5, v1
    v_mad_u32_u24 v3, v2, 6, v3
    v_lshlrev_b32 v3, 7, v3
    v_add_u32 v3, s7, v3
    v_min_u32 v3, code_end-k_pc-4, v3
    global_load_dword v0, v3, s[4:5]
    s_and_b32 s7, s3, 3
    s_lshr_b32 s14, s7, 1
    s_lshl_b32 s60, s2, 1
    s_add_u32 s60, s60, s14
    s_lshl_b32 s13, s60, 9
    s_and_b32 s14, s7, 1
    s_lshl_b32 s14, s14, 7
    s_add_u32 s13, s13, s14
    s_and_b32 s14, s3, 4
    s_lshl_b32 s14, s14, 6
    s_add_u32 s13, s13, s14
    v_lshl_add_u32 v8, v1, 1, s13
    s_lshl_b32 s14, s60, 1
    v_mov_b32 v9, s14
    s_cmp_ge_u32 s2, 224
    s_cbranch_scc1 k_npl
    s_waitcnt lgkmcnt(0)
    global_load_ushort v238, v9, s[30:31]
    global_load_ushort v239, v8, s[18:19] nt
    global_load_ushort v11, v8, s[20:21] nt
    global_load_ushort v12, v8, s[22:23] nt
    global_load_ushort v216, v8, s[24:25] nt
    global_load_ushort v217, v8, s[26:27] nt
    global_load_ushort v218, v8, s[28:29] nt
k_npl:
    s_and_b32 s10, s2, 6
    s_lshl_b32 s10, s10, 1
    s_add_u32 s10, s10, s8
    s_and_b32 s9, s2, 1
    s_mul_i32 s11, s9, 7
    s_lshr_b32 s12, s6, 2
    s_add_u32 s11, s11, s12
    v_lshlrev_b32 v10, 4, v1
    s_lshl_b32 s42, s8, 1
    s_add_u32 s42, s42, s12
    s_sub_u32 s43, s42, 7
    s_cmp_ge_u32 s42, 7
    s_cselect_b32 s42, s43, s42
    v_lshrrev_b32 v20, 3, v1
    v_lshrrev_b32 v21, 4, v1
    v_and_b32 v22, 7, v1
    s_lshl_b32 s13, s7, 4
    v_add_u32 v25, s13, v20
    v_mul_u32_u24 v25, 3584, v25
    s_lshl_b32 s13, s11, 8
    v_add_u32 v25, s13, v25
    v_and_b32 v26, 1, v21
    v_lshlrev_b32 v26, 1, v26
    v_xor_b32 v26, v22, v26
    v_lshl_add_u32 v240, v26, 4, v25
    v_add_u32 v241, 27648, v240
    v_xor_b32 v26, 4, v26
    v_lshl_add_u32 v242, v26, 4, v25
    v_add_u32 v243, 27648, v242
    s_lshl_b32 s15, s7, 11
    s_mov_b32 s50, 1605632
    s_mov_b32 s51, 0x20000
    s_mov_b32 s54, 1605632
    s_mov_b32 s55, 0x20000
    s_cmp_eq_u32 s12, 7
    s_cbranch_scc1 k_spare
    v_xor_b32 v23, v22, v21
    v_xor_b32 v24, 4, v23
    s_lshl_b32 s13, s7, 5
    v_add_u32 v25, s13, v20
    v_mul_u32_u24 v25, 896, v25
    v_lshl_add_u32 v232, v23, 4, v25
    v_lshl_add_u32 v233, v24, 4, v25
    v_add_u32 v233, 6144, v233
    v_add_u32 v234, 12288, v232
    v_add_u32 v235, 12288, v233
    s_lshl_b32 s14, s7, 12
    s_lshl_b32 s56, s42, 7
    s_mul_i32 s57, s42, 229376
    s_mul_i32 s13, s10, 114688
    s_mov_b32 s46, 114688
    s_mov_b32 s47, 0x20000
    s_mul_i32 s63, s3, 4608
    s_mov_b32 s48, s32
    s_mov_b32 s49, s33
    s_mov_b32 s52, s34
    s_mov_b32 s53, s35
    s_add_u32 s44, s16, s13
    s_addc_u32 s45, s17, 0
    s_cmp_lt_u32 s3, 4
    s_cbranch_scc1 k_x0
    s_add_u32 m0, s15, 114688
    s_mov_b32 s58, s57
    buffer_load_dwordx4 v240, s[48:51], s58 offen offset:0  lds
    buffer_load_dwordx4 v241, s[48:51], s58 offen offset:1024  lds
    s_add_u32 m0, s15, 122880
    s_add_u32 s57, s57, 229376
    buffer_load_dwordx4 v242, s[52:55], s58 offen offset:0  lds
    buffer_load_dwordx4 v243, s[52:55], s58 offen offset:1024  lds
    s_cmp_eq_u32 s57, 1605632
    s_cselect_b32 s57, 0, s57
    s_add_u32 m0, s14, 98304
    s_mov_b32 s58, s56
    buffer_load_dwordx4 v232, s[44:47], s58 offen offset:0  lds
    buffer_load_dwordx4 v233, s[44:47], s58 offen offset:1024  lds
    buffer_load_dwordx4 v234, s[44:47], s58 offen offset:2048  lds
    buffer_load_dwordx4 v235, s[44:47], s58 offen offset:3072  lds
    s_add_u32 s56, s56, 128
    s_cmp_eq_u32 s56, 896
    s_cselect_b32 s56, 0, s56
    s_and_b32 s9, s2, 7
    s_lshl_b32 s9, s9, 2
    s_add_u32 s9, s9, s8
    s_mul_i32 s13, s9, 229376
    s_mul_i32 s58, s7, 28672
    s_add_u32 s13, s13, s58
    s_add_u32 s16, s40, s13
    s_addc_u32 s17, s41, 0
    s_mov_b32 s18, 143360
    s_mov_b32 s19, 0x20000
    s_mov_b32 s20, s36
    s_mov_b32 s21, s37
    s_mov_b32 s22, 1605632
    s_mov_b32 s23, 0x20000
    s_mul_i32 s25, s7, 7
    s_lshl_b32 s26, s12, 7
    s_add_u32 s58, s42, 0
    s_sub_u32 s59, s58, 7
    s_min_u32 s58, s58, s59
    s_lshl_b32 s4, s58, 12
    s_add_u32 s58, s58, s25
    s_lshr_b32 s59, s58, 1
    s_mul_i32 s59, s59, 114688
    s_and_b32 s58, s58, 1
    s_mul_i32 s58, s58, 28672
    s_add_u32 s58, s58, s59
    s_add_u32 s32, s58, s26
    s_add_u32 s58, s42, 1
    s_sub_u32 s59, s58, 7
    s_min_u32 s58, s58, s59
    s_lshl_b32 s5, s58, 12
    s_add_u32 s58, s58, s25
    s_lshr_b32 s59, s58, 1
    s_mul_i32 s59, s59, 114688
    s_and_b32 s58, s58, 1
    s_mul_i32 s58, s58, 28672
    s_add_u32 s58, s58, s59
    s_add_u32 s33, s58, s26
    s_add_u32 s58, s42, 2
    s_sub_u32 s59, s58, 7
    s_min_u32 s58, s58, s59
    s_lshl_b32 s6, s58, 12
    s_add_u32 s58, s58, s25
    s_lshr_b32 s59, s58, 1
    s_mul_i32 s59, s59, 114688
    s_and_b32 s58, s58, 1
    s_mul_i32 s58, s58, 28672
    s_add_u32 s58, s58, s59
    s_add_u32 s34, s58, s26
    s_add_u32 s58, s42, 3
    s_sub_u32 s59, s58, 7
    s_min_u32 s58, s58, s59
    s_lshl_b32 s39, s58, 12
    s_add_u32 s58, s58, s25
    s_lshr_b32 s59, s58, 1
    s_mul_i32 s59, s59, 114688
    s_and_b32 s58, s58, 1
    s_mul_i32 s58, s58, 28672
    s_add_u32 s58, s58, s59
    s_add_u32 s35, s58, s26
    s_add_u32 s58, s42, 4
    s_sub_u32 s59, s58, 7
    s_min_u32 s58, s58, s59
    s_lshl_b32 s0, s58, 12
    s_add_u32 s58, s58, s25
    s_lshr_b32 s59, s58, 1
    s_mul_i32 s59, s59, 114688
    s_and_b32 s58, s58, 1
    s_mul_i32 s58, s58, 28672
    s_add_u32 s58, s58, s59
    s_add_u32 s36, s58, s26
    s_add_u32 s58, s42, 5
    s_sub_u32 s59, s58, 7
    s_min_u32 s58, s58, s59
    s_lshl_b32 s1, s58, 12
    s_add_u32 s58, s58, s25
    s_lshr_b32 s59, s58, 1
    s_mul_i32 s59, s59, 114688
    s_and_b32 s58, s58, 1
    s_mul_i32 s58, s58, 28672
    s_add_u32 s58, s58, s59
    s_add_u32 s37, s58, s26
    s_add_u32 s58, s42, 6
    s_sub_u32 s59, s58, 7
    s_min_u32 s58, s58, s59
    s_lshl_b32 s60, s58, 12
    s_add_u32 s58, s58, s25
    s_lshr_b32 s59, s58, 1
    s_mul_i32 s59, s59, 114688
    s_and_b32 s58, s58, 1
    s_mul_i32 s58, s58, 28672
    s_add_u32 s58, s58, s59
    s_add_u32 s38, s58, s26
    s_branch k_w0
k_x0:
    s_load_dwordx2 s[4:5], s[0:1], 64
    s_add_u32 s57, s42, 1
    s_sub_u32 s13, s57, 7
    s_cmp_ge_u32 s57, 7
    s_cselect_b32 s57, s13, s57
    s_mul_i32 s57, s57, 229376
k_w0:
    v_and_b32 v4, 15, v1
    v_lshlrev_b32 v5, 2, v21
    v_lshlrev_b32 v6, 6, v21
    v_lshl_add_u32 v247, v4, 4, v5
    v_lshl_add_u32 v248, v4, 3, v5
    v_lshl_add_u32 v249, v4, 2, v6
    v_cmp_gt_u32 vcc, 2, v21
    s_nop 1
    v_cndmask_b32 v248, v249, v248, vcc
    v_lshl_add_u32 v249, v4, 1, v6
    v_lshl_add_u32 v247, v247, 2, s63
    v_lshl_add_u32 v248, v248, 2, s63
    v_lshl_add_u32 v249, v249, 2, s63
    v_and_b32 v6, 31, v1
    v_lshrrev_b32 v7, 5, v1
    v_bfe_u32 v4, v1, 1, 3
    v_xor_b32 v7, v7, v4
    v_lshlrev_b32 v7, 4, v7
    v_lshl_add_u32 v6, v6, 7, v7
    s_lshr_b32 s13, s7, 1
    s_lshl_b32 s13, s13, 13
    v_add_u32 v2, s13, v6
    v_lshlrev_b32 v6, 9, v1
    v_and_b32 v6, 0x2000, v6
    v_lshlrev_b32 v7, 5, v1
    v_and_b32 v7, 0x580, v7
    v_and_b32 v4, 3, v1
    v_lshlrev_b32 v4, 3, v4
    v_add3_u32 v6, v6, v7, v4
    v_bfe_u32 v7, v1, 3, 2
    s_and_b32 s13, s7, 1
    s_lshl_b32 s13, s13, 1
    v_xor_b32 v7, s13, v7
    v_lshl_add_u32 v3, v7, 5, v6
    s_lshl_b32 s13, s10, 1
    s_lshr_b32 s58, s7, 1
    s_add_u32 s13, s13, s58
    s_mul_i32 s13, s13, 56
    s_lshl_b32 s58, s11, 1
    s_add_u32 s13, s13, s58
    s_and_b32 s58, s7, 1
    s_add_u32 s13, s13, s58
    s_lshr_b32 s58, s3, 2
    s_mul_i32 s58, s58, 28
    s_add_u32 s13, s13, s58
    s_lshl_b32 s13, s13, 12
    v_and_b32 v14, 15, v1
    v_lshl_add_u32 v14, v14, 4, s13
    v_bfe_u32 v15, v1, 4, 1
    v_lshl_add_u32 v14, v15, 10, v14
    v_lshrrev_b32 v15, 5, v1
    v_lshl_add_u32 v14, v15, 8, v14
    s_mov_b32 s62, 0xbfb8aa3b
    s_lshl_b32 s13, s2, 7
    s_add_u32 s13, s13, 16842752
    s_add_u32 s28, s40, s13
    s_addc_u32 s29, s41, 0
    v_mov_b32 v245, v9
    v_and_b32 v18, 15, v1
    v_mul_u32_u24 v18, 288, v18
    v_and_b32 v19, 48, v1
    v_add3_u32 v18, v18, v19, s63
    s_cmp_lt_u32 s3, 4
    s_cbranch_scc1 k_x1
    s_waitcnt vmcnt(8)
    s_branch k_kg
k_x1:
    s_waitcnt vmcnt(0)
k_kg:
    s_mov_b32 m0, s63
    v_lshlrev_b32 v238, 16, v238
    v_mul_f32 v16, 0x3fb8aa3b, v238
    v_exp_f32 v16, v16
    v_lshlrev_b32 v239, 16, v239
    v_lshlrev_b32 v11, 16, v11
    v_lshlrev_b32 v12, 16, v12
    v_lshlrev_b32 v216, 16, v216
    v_lshlrev_b32 v217, 16, v217
    v_lshlrev_b32 v218, 16, v218
    v_cvt_pk_bf16_f32 v16, v16, v16
    v_and_b32 v16, 0xffff0000, v16
    v_mul_f32 v8, 0x3fb8aa3b, v16
    v_mul_f32 v9, 0.15915494, v16
    v_mul_f32 v17, v239, v8
    v_mul_f32 v11, v11, v9
    v_mul_f32 v12, v12, v16
    v_mul_f32 v216, v216, v16
    v_mul_f32 v68, v217, v12
    v_mul_f32 v69, v217, v216
    v_fma_f32 v68, -v218, v216, v68
    v_fma_f32 v69, -v218, v12, -v69
    v_mul_f32 v92, 0x41800000, v17
    v_mul_f32 v93, 0x41800000, v11
    v_mul_f32 v96, 0x43800000, v17
    v_mul_f32 v97, 0x43800000, v11
    v_exp_f32 v92, v92
    v_fract_f32 v93, v93
    v_exp_f32 v94, v17
    v_fract_f32 v95, v11
    v_exp_f32 v96, v96
    v_fract_f32 v97, v97
    v_cos_f32 v84, v93
    v_sin_f32 v85, v93
    v_cos_f32 v22, v95
    v_sin_f32 v23, v95
    v_cos_f32 v52, v97
    v_sin_f32 v53, v97
    v_pk_mul_f32 v[84:85], v[84:85], v[92:93] op_sel_hi:[1,0] neg_hi:[1,0]
    v_pk_mul_f32 v[22:23], v[22:23], v[94:95] op_sel_hi:[1,0]
    v_pk_mul_f32 v[52:53], v[52:53], v[96:97] op_sel_hi:[1,0]
    v_pk_mul_f32 v[86:87], v[84:85], v[84:85] op_sel_hi:[1,0]
    v_pk_mul_f32 v[70:71], v[68:69], v[84:85] op_sel_hi:[1,0]
    v_pk_mul_f32 v[24:25], v[22:23], v[22:23] op_sel_hi:[1,0]
    v_pk_mul_f32 v[54:55], v[52:53], v[52:53] op_sel_hi:[1,0]
    v_pk_fma_f32 v[86:87], v[84:85], v[84:85], v[86:87] op_sel:[1,1,0] op_sel_hi:[0,1,1] neg_lo:[1,0,0]
    v_pk_fma_f32 v[70:71], v[68:69], v[84:85], v[70:71] op_sel:[1,1,0] op_sel_hi:[0,1,1] neg_lo:[1,0,0]
    v_pk_fma_f32 v[24:25], v[22:23], v[22:23], v[24:25] op_sel:[1,1,0] op_sel_hi:[0,1,1] neg_lo:[1,0,0]
    v_pk_fma_f32 v[54:55], v[52:53], v[52:53], v[54:55] op_sel:[1,1,0] op_sel_hi:[0,1,1] neg_lo:[1,0,0]
    v_pk_mul_f32 v[72:73], v[68:69], v[86:87] op_sel_hi:[1,0]
    v_pk_mul_f32 v[74:75], v[70:71], v[86:87] op_sel_hi:[1,0]
    v_pk_mul_f32 v[26:27], v[24:25], v[22:23] op_sel_hi:[1,0]
    v_pk_mul_f32 v[28:29], v[24:25], v[24:25] op_sel_hi:[1,0]
    v_pk_fma_f32 v[72:73], v[68:69], v[86:87], v[72:73] op_sel:[1,1,0] op_sel_hi:[0,1,1] neg_lo:[1,0,0]
    v_pk_fma_f32 v[74:75], v[70:71], v[86:87], v[74:75] op_sel:[1,1,0] op_sel_hi:[0,1,1] neg_lo:[1,0,0]
    v_pk_fma_f32 v[26:27], v[24:25], v[22:23], v[26:27] op_sel:[1,1,0] op_sel_hi:[0,1,1] neg_lo:[1,0,0]
    v_pk_fma_f32 v[28:29], v[24:25], v[24:25], v[28:29] op_sel:[1,1,0] op_sel_hi:[0,1,1] neg_lo:[1,0,0]
    v_cvt_pk_bf16_f32 v108, v68, v69
    v_cvt_pk_bf16_f32 v109, v70, v71
    v_cvt_pk_bf16_f32 v110, v72, v73
    v_cvt_pk_bf16_f32 v111, v74, v75
    ds_write_addtid_b32 v108 offset:0
    ds_write_addtid_b32 v109 offset:288
    ds_write_addtid_b32 v110 offset:576
    ds_write_addtid_b32 v111 offset:864
    v_pk_mul_f32 v[76:77], v[72:73], v[86:87] op_sel_hi:[1,0]
    v_pk_mul_f32 v[78:79], v[74:75], v[86:87] op_sel_hi:[1,0]
    v_pk_mul_f32 v[56:57], v[54:55], v[52:53] op_sel_hi:[1,0]
    v_pk_mul_f32 v[58:59], v[54:55], v[54:55] op_sel_hi:[1,0]
    v_pk_fma_f32 v[76:77], v[72:73], v[86:87], v[76:77] op_sel:[1,1,0] op_sel_hi:[0,1,1] neg_lo:[1,0,0]
    v_pk_fma_f32 v[78:79], v[74:75], v[86:87], v[78:79] op_sel:[1,1,0] op_sel_hi:[0,1,1] neg_lo:[1,0,0]
    v_pk_fma_f32 v[56:57], v[54:55], v[52:53], v[56:57] op_sel:[1,1,0] op_sel_hi:[0,1,1] neg_lo:[1,0,0]
    v_pk_fma_f32 v[58:59], v[54:55], v[54:55], v[58:59] op_sel:[1,1,0] op_sel_hi:[0,1,1] neg_lo:[1,0,0]
    v_pk_mul_f32 v[80:81], v[76:77], v[86:87] op_sel_hi:[1,0]
    v_pk_mul_f32 v[82:83], v[78:79], v[86:87] op_sel_hi:[1,0]
    v_pk_fma_f32 v[80:81], v[76:77], v[86:87], v[80:81] op_sel:[1,1,0] op_sel_hi:[0,1,1] neg_lo:[1,0,0]
    v_pk_fma_f32 v[82:83], v[78:79], v[86:87], v[82:83] op_sel:[1,1,0] op_sel_hi:[0,1,1] neg_lo:[1,0,0]
    v_cvt_pk_bf16_f32 v112, v76, v77
    v_cvt_pk_bf16_f32 v113, v78, v79
    v_cvt_pk_bf16_f32 v114, v80, v81
    v_cvt_pk_bf16_f32 v115, v82, v83
    ds_write_addtid_b32 v112 offset:1152
    ds_write_addtid_b32 v113 offset:1440
    ds_write_addtid_b32 v114 offset:1728
    ds_write_addtid_b32 v115 offset:2016
    v_pk_mul_f32 v[92:93], v[80:81], v[86:87] op_sel_hi:[1,0]
    v_pk_mul_f32 v[94:95], v[82:83], v[86:87] op_sel_hi:[1,0]
    v_pk_fma_f32 v[92:93], v[80:81], v[86:87], v[92:93] op_sel:[1,1,0] op_sel_hi:[0,1,1] neg_lo:[1,0,0]
    v_pk_fma_f32 v[94:95], v[82:83], v[86:87], v[94:95] op_sel:[1,1,0] op_sel_hi:[0,1,1] neg_lo:[1,0,0]
    v_pk_mul_f32 v[96:97], v[92:93], v[86:87] op_sel_hi:[1,0]
    v_pk_mul_f32 v[98:99], v[94:95], v[86:87] op_sel_hi:[1,0]
    v_pk_fma_f32 v[96:97], v[92:93], v[86:87], v[96:97] op_sel:[1,1,0] op_sel_hi:[0,1,1] neg_lo:[1,0,0]
    v_pk_fma_f32 v[98:99], v[94:95], v[86:87], v[98:99] op_sel:[1,1,0] op_sel_hi:[0,1,1] neg_lo:[1,0,0]
    v_cvt_pk_bf16_f32 v108, v92, v93
    v_cvt_pk_bf16_f32 v109, v94, v95
    v_cvt_pk_bf16_f32 v110, v96, v97
    v_cvt_pk_bf16_f32 v111, v98, v99
    ds_write_addtid_b32 v108 offset:2304
    ds_write_addtid_b32 v109 offset:2592
    ds_write_addtid_b32 v110 offset:2880
    ds_write_addtid_b32 v111 offset:3168
    v_pk_mul_f32 v[100:101], v[96:97], v[86:87] op_sel_hi:[1,0]
    v_pk_mul_f32 v[102:103], v[98:99], v[86:87] op_sel_hi:[1,0]
    v_pk_fma_f32 v[100:101], v[96:97], v[86:87], v[100:101] op_sel:[1,1,0] op_sel_hi:[0,1,1] neg_lo:[1,0,0]
    v_pk_fma_f32 v[102:103], v[98:99], v[86:87], v[102:103] op_sel:[1,1,0] op_sel_hi:[0,1,1] neg_lo:[1,0,0]
    v_pk_mul_f32 v[104:105], v[100:101], v[86:87] op_sel_hi:[1,0]
    v_pk_mul_f32 v[106:107], v[102:103], v[86:87] op_sel_hi:[1,0]
    v_pk_fma_f32 v[104:105], v[100:101], v[86:87], v[104:105] op_sel:[1,1,0] op_sel_hi:[0,1,1] neg_lo:[1,0,0]
    v_pk_fma_f32 v[106:107], v[102:103], v[86:87], v[106:107] op_sel:[1,1,0] op_sel_hi:[0,1,1] neg_lo:[1,0,0]
    v_cvt_pk_bf16_f32 v112, v100, v101
    v_cvt_pk_bf16_f32 v113, v102, v103
    v_cvt_pk_bf16_f32 v114, v104, v105
    v_cvt_pk_bf16_f32 v115, v106, v107
    ds_write_addtid_b32 v112 offset:3456
    ds_write_addtid_b32 v113 offset:3744
    ds_write_addtid_b32 v114 offset:4032
    ds_write_addtid_b32 v115 offset:4320
    ds_read_b128 v[116:119], v18 offset:0
    ds_read_b128 v[120:123], v18 offset:64
    ds_read_b128 v[124:127], v18 offset:128
    ds_read_b128 v[128:131], v18 offset:192
    v_mov_b32 v108, 0x3f80
    v_cvt_pk_bf16_f32 v109, v22, v23
    v_cvt_pk_bf16_f32 v110, v24, v25
    v_cvt_pk_bf16_f32 v111, v26, v27
    ds_write_addtid_b32 v108 offset:0
    ds_write_addtid_b32 v109 offset:288
    ds_write_addtid_b32 v110 offset:576
    ds_write_addtid_b32 v111 offset:864
    v_pk_mul_f32 v[30:31], v[28:29], v[22:23] op_sel_hi:[1,0]
    v_pk_mul_f32 v[32:33], v[28:29], v[24:25] op_sel_hi:[1,0]
    v_pk_mul_f32 v[34:35], v[28:29], v[26:27] op_sel_hi:[1,0]
    v_pk_mul_f32 v[36:37], v[28:29], v[28:29] op_sel_hi:[1,0]
    v_pk_fma_f32 v[30:31], v[28:29], v[22:23], v[30:31] op_sel:[1,1,0] op_sel_hi:[0,1,1] neg_lo:[1,0,0]
    v_pk_fma_f32 v[32:33], v[28:29], v[24:25], v[32:33] op_sel:[1,1,0] op_sel_hi:[0,1,1] neg_lo:[1,0,0]
    v_pk_fma_f32 v[34:35], v[28:29], v[26:27], v[34:35] op_sel:[1,1,0] op_sel_hi:[0,1,1] neg_lo:[1,0,0]
    v_pk_fma_f32 v[36:37], v[28:29], v[28:29], v[36:37] op_sel:[1,1,0] op_sel_hi:[0,1,1] neg_lo:[1,0,0]
    v_cvt_pk_bf16_f32 v112, v28, v29
    v_cvt_pk_bf16_f32 v113, v30, v31
    v_cvt_pk_bf16_f32 v114, v32, v33
    v_cvt_pk_bf16_f32 v115, v34, v35
    ds_write_addtid_b32 v112 offset:1152
    ds_write_addtid_b32 v113 offset:1440
    ds_write_addtid_b32 v114 offset:1728
    ds_write_addtid_b32 v115 offset:2016
    v_pk_mul_f32 v[38:39], v[36:37], v[22:23] op_sel_hi:[1,0]
    v_pk_mul_f32 v[40:41], v[36:37], v[24:25] op_sel_hi:[1,0]
    v_pk_mul_f32 v[42:43], v[36:37], v[26:27] op_sel_hi:[1,0]
    v_pk_fma_f32 v[38:39], v[36:37], v[22:23], v[38:39] op_sel:[1,1,0] op_sel_hi:[0,1,1] neg_lo:[1,0,0]
    v_pk_fma_f32 v[40:41], v[36:37], v[24:25], v[40:41] op_sel:[1,1,0] op_sel_hi:[0,1,1] neg_lo:[1,0,0]
    v_pk_fma_f32 v[42:43], v[36:37], v[26:27], v[42:43] op_sel:[1,1,0] op_sel_hi:[0,1,1] neg_lo:[1,0,0]
    v_cvt_pk_bf16_f32 v108, v36, v37
    v_cvt_pk_bf16_f32 v109, v38, v39
    v_cvt_pk_bf16_f32 v110, v40, v41
    v_cvt_pk_bf16_f32 v111, v42, v43
    ds_write_addtid_b32 v108 offset:2304
    ds_write_addtid_b32 v109 offset:2592
    ds_write_addtid_b32 v110 offset:2880
    ds_write_addtid_b32 v111 offset:3168
    v_pk_mul_f32 v[44:45], v[36:37], v[28:29] op_sel_hi:[1,0]
    v_pk_mul_f32 v[46:47], v[36:37], v[30:31] op_sel_hi:[1,0]
    v_pk_mul_f32 v[48:49], v[36:37], v[32:33] op_sel_hi:[1,0]
    v_pk_mul_f32 v[50:51], v[36:37], v[34:35] op_sel_hi:[1,0]
    v_pk_fma_f32 v[44:45], v[36:37], v[28:29], v[44:45] op_sel:[1,1,0] op_sel_hi:[0,1,1] neg_lo:[1,0,0]
    v_pk_fma_f32 v[46:47], v[36:37], v[30:31], v[46:47] op_sel:[1,1,0] op_sel_hi:[0,1,1] neg_lo:[1,0,0]
    v_pk_fma_f32 v[48:49], v[36:37], v[32:33], v[48:49] op_sel:[1,1,0] op_sel_hi:[0,1,1] neg_lo:[1,0,0]
    v_pk_fma_f32 v[50:51], v[36:37], v[34:35], v[50:51] op_sel:[1,1,0] op_sel_hi:[0,1,1] neg_lo:[1,0,0]
    v_cvt_pk_bf16_f32 v112, v44, v45
    v_cvt_pk_bf16_f32 v113, v46, v47
    v_cvt_pk_bf16_f32 v114, v48, v49
    v_cvt_pk_bf16_f32 v115, v50, v51
    ds_write_addtid_b32 v112 offset:3456
    ds_write_addtid_b32 v113 offset:3744
    ds_write_addtid_b32 v114 offset:4032
    ds_write_addtid_b32 v115 offset:4320
    ds_read_b128 v[132:135], v18 offset:0
    ds_read_b128 v[136:139], v18 offset:64
    ds_read_b128 v[140:143], v18 offset:128
    ds_read_b128 v[144:147], v18 offset:192
    v_pk_mul_f32 v[94:95], v[52:53], v[24:25] op_sel_hi:[1,0]
    v_pk_mul_f32 v[96:97], v[52:53], v[28:29] op_sel_hi:[1,0]
    v_pk_mul_f32 v[98:99], v[52:53], v[32:33] op_sel_hi:[1,0]
    v_pk_fma_f32 v[94:95], v[52:53], v[24:25], v[94:95] op_sel:[1,1,0] op_sel_hi:[0,1,1] neg_lo:[1,0,0]
    v_pk_fma_f32 v[96:97], v[52:53], v[28:29], v[96:97] op_sel:[1,1,0] op_sel_hi:[0,1,1] neg_lo:[1,0,0]
    v_pk_fma_f32 v[98:99], v[52:53], v[32:33], v[98:99] op_sel:[1,1,0] op_sel_hi:[0,1,1] neg_lo:[1,0,0]
    v_cvt_pk_bf16_f32 v108, v52, v53
    v_cvt_pk_bf16_f32 v109, v94, v95
    v_cvt_pk_bf16_f32 v110, v96, v97
    v_cvt_pk_bf16_f32 v111, v98, v99
    ds_write_addtid_b32 v108 offset:0
    ds_write_addtid_b32 v109 offset:288
    ds_write_addtid_b32 v110 offset:576
    ds_write_addtid_b32 v111 offset:864
    v_pk_mul_f32 v[100:101], v[52:53], v[36:37] op_sel_hi:[1,0]
    v_pk_mul_f32 v[102:103], v[52:53], v[40:41] op_sel_hi:[1,0]
    v_pk_mul_f32 v[104:105], v[52:53], v[44:45] op_sel_hi:[1,0]
    v_pk_mul_f32 v[106:107], v[52:53], v[48:49] op_sel_hi:[1,0]
    v_pk_fma_f32 v[100:101], v[52:53], v[36:37], v[100:101] op_sel:[1,1,0] op_sel_hi:[0,1,1] neg_lo:[1,0,0]
    v_pk_fma_f32 v[102:103], v[52:53], v[40:41], v[102:103] op_sel:[1,1,0] op_sel_hi:[0,1,1] neg_lo:[1,0,0]
    v_pk_fma_f32 v[104:105], v[52:53], v[44:45], v[104:105] op_sel:[1,1,0] op_sel_hi:[0,1,1] neg_lo:[1,0,0]
    v_pk_fma_f32 v[106:107], v[52:53], v[48:49], v[106:107] op_sel:[1,1,0] op_sel_hi:[0,1,1] neg_lo:[1,0,0]
    v_cvt_pk_bf16_f32 v112, v100, v101
    v_cvt_pk_bf16_f32 v113, v102, v103
    v_cvt_pk_bf16_f32 v114, v104, v105
    v_cvt_pk_bf16_f32 v115, v106, v107
    ds_write_addtid_b32 v112 offset:1152
    ds_write_addtid_b32 v113 offset:1440
    ds_write_addtid_b32 v114 offset:1728
    ds_write_addtid_b32 v115 offset:2016
    v_pk_mul_f32 v[92:93], v[54:55], v[28:29] op_sel_hi:[1,0]
    v_pk_mul_f32 v[94:95], v[54:55], v[36:37] op_sel_hi:[1,0]
    v_pk_mul_f32 v[96:97], v[54:55], v[44:45] op_sel_hi:[1,0]
    v_pk_fma_f32 v[92:93], v[54:55], v[28:29], v[92:93] op_sel:[1,1,0] op_sel_hi:[0,1,1] neg_lo:[1,0,0]
    v_pk_fma_f32 v[94:95], v[54:55], v[36:37], v[94:95] op_sel:[1,1,0] op_sel_hi:[0,1,1] neg_lo:[1,0,0]
    v_pk_fma_f32 v[96:97], v[54:55], v[44:45], v[96:97] op_sel:[1,1,0] op_sel_hi:[0,1,1] neg_lo:[1,0,0]
    s_waitcnt lgkmcnt(8)
    v_mfma_f32_16x16x32_bf16 v[164:167], v[132:135], v[116:119], 0
    v_mfma_f32_16x16x32_bf16 v[164:167], v[136:139], v[120:123], v[164:167]
    v_mfma_f32_16x16x32_bf16 v[164:167], v[140:143], v[124:127], v[164:167]
    v_mfma_f32_16x16x32_bf16 v[164:167], v[144:147], v[128:131], v[164:167]
    v_cvt_pk_bf16_f32 v108, v54, v55
    v_cvt_pk_bf16_f32 v109, v92, v93
    v_cvt_pk_bf16_f32 v110, v94, v95
    v_cvt_pk_bf16_f32 v111, v96, v97
    ds_write_addtid_b32 v108 offset:2304
    ds_write_addtid_b32 v109 offset:2592
    ds_write_addtid_b32 v110 offset:2880
    ds_write_addtid_b32 v111 offset:3168
    v_pk_mul_f32 v[98:99], v[56:57], v[28:29] op_sel_hi:[1,0]
    v_pk_mul_f32 v[100:101], v[56:57], v[36:37] op_sel_hi:[1,0]
    v_pk_mul_f32 v[102:103], v[56:57], v[44:45] op_sel_hi:[1,0]
    v_pk_fma_f32 v[98:99], v[56:57], v[28:29], v[98:99] op_sel:[1,1,0] op_sel_hi:[0,1,1] neg_lo:[1,0,0]
    v_pk_fma_f32 v[100:101], v[56:57], v[36:37], v[100:101] op_sel:[1,1,0] op_sel_hi:[0,1,1] neg_lo:[1,0,0]
    v_pk_fma_f32 v[102:103], v[56:57], v[44:45], v[102:103] op_sel:[1,1,0] op_sel_hi:[0,1,1] neg_lo:[1,0,0]
    v_cvt_pk_bf16_f32 v112, v56, v57
    v_cvt_pk_bf16_f32 v113, v98, v99
    v_cvt_pk_bf16_f32 v114, v100, v101
    v_cvt_pk_bf16_f32 v115, v102, v103
    ds_write_addtid_b32 v112 offset:3456
    ds_write_addtid_b32 v113 offset:3744
    ds_write_addtid_b32 v114 offset:4032
    ds_write_addtid_b32 v115 offset:4320
    ds_read_b128 v[148:151], v18 offset:0
    ds_read_b128 v[152:155], v18 offset:64
    ds_read_b128 v[156:159], v18 offset:128
    ds_read_b128 v[160:163], v18 offset:192
    v_pk_mul_f32 v[60:61], v[58:59], v[52:53] op_sel_hi:[1,0]
    v_pk_mul_f32 v[62:63], v[58:59], v[54:55] op_sel_hi:[1,0]
    v_pk_mul_f32 v[64:65], v[58:59], v[56:57] op_sel_hi:[1,0]
    v_pk_mul_f32 v[66:67], v[58:59], v[58:59] op_sel_hi:[1,0]
    v_pk_fma_f32 v[60:61], v[58:59], v[52:53], v[60:61] op_sel:[1,1,0] op_sel_hi:[0,1,1] neg_lo:[1,0,0]
    v_pk_fma_f32 v[62:63], v[58:59], v[54:55], v[62:63] op_sel:[1,1,0] op_sel_hi:[0,1,1] neg_lo:[1,0,0]
    v_pk_fma_f32 v[64:65], v[58:59], v[56:57], v[64:65] op_sel:[1,1,0] op_sel_hi:[0,1,1] neg_lo:[1,0,0]
    v_pk_fma_f32 v[66:67], v[58:59], v[58:59], v[66:67] op_sel:[1,1,0] op_sel_hi:[0,1,1] neg_lo:[1,0,0]
    v_cvt_pk_bf16_f32 v108, v58, v59
    v_cvt_pk_bf16_f32 v109, v60, v61
    v_cvt_pk_bf16_f32 v110, v62, v63
    v_cvt_pk_bf16_f32 v111, v64, v65
    ds_write_addtid_b32 v108 offset:0
    ds_write_addtid_b32 v109 offset:576
    ds_write_addtid_b32 v110 offset:1152
    ds_write_addtid_b32 v111 offset:1728
    v_pk_mul_f32 v[92:93], v[58:59], v[36:37] op_sel_hi:[1,0]
    v_pk_mul_f32 v[94:95], v[60:61], v[36:37] op_sel_hi:[1,0]
    v_pk_mul_f32 v[96:97], v[62:63], v[36:37] op_sel_hi:[1,0]
    v_pk_mul_f32 v[98:99], v[64:65], v[36:37] op_sel_hi:[1,0]
    v_pk_fma_f32 v[92:93], v[58:59], v[36:37], v[92:93] op_sel:[1,1,0] op_sel_hi:[0,1,1] neg_lo:[1,0,0]
    v_pk_fma_f32 v[94:95], v[60:61], v[36:37], v[94:95] op_sel:[1,1,0] op_sel_hi:[0,1,1] neg_lo:[1,0,0]
    v_pk_fma_f32 v[96:97], v[62:63], v[36:37], v[96:97] op_sel:[1,1,0] op_sel_hi:[0,1,1] neg_lo:[1,0,0]
    v_pk_fma_f32 v[98:99], v[64:65], v[36:37], v[98:99] op_sel:[1,1,0] op_sel_hi:[0,1,1] neg_lo:[1,0,0]
    v_cvt_pk_bf16_f32 v112, v92, v93
    v_cvt_pk_bf16_f32 v113, v94, v95
    v_cvt_pk_bf16_f32 v114, v96, v97
    v_cvt_pk_bf16_f32 v115, v98, v99
    ds_write_addtid_b32 v112 offset:288
    ds_write_addtid_b32 v113 offset:864
    ds_write_addtid_b32 v114 offset:1440
    ds_write_addtid_b32 v115 offset:2016
    v_cvt_pk_bf16_f32 v108, v66, v67
    ds_write_addtid_b32 v108 offset:2304
    ds_read_b128 v[132:135], v18 offset:0
    ds_read_b128 v[136:139], v18 offset:64
    ds_read_b128 v[140:143], v18 offset:128
    ds_read_b128 v[144:147], v18 offset:192
    s_waitcnt lgkmcnt(13)
    v_mfma_f32_16x16x32_bf16 v[168:171], v[148:151], v[116:119], 0
    v_mfma_f32_16x16x32_bf16 v[168:171], v[152:155], v[120:123], v[168:171]
    v_mfma_f32_16x16x32_bf16 v[168:171], v[156:159], v[124:127], v[168:171]
    v_mfma_f32_16x16x32_bf16 v[168:171], v[160:163], v[128:131], v[168:171]
    s_waitcnt lgkmcnt(0)
    v_mfma_f32_16x16x32_bf16 v[172:175], v[132:135], v[116:119], 0
    v_mfma_f32_16x16x32_bf16 v[172:175], v[136:139], v[120:123], v[172:175]
    v_mfma_f32_16x16x32_bf16 v[172:175], v[140:143], v[124:127], v[172:175]
    v_mfma_f32_16x16x32_bf16 v[172:175], v[144:147], v[128:131], v[172:175]
    ds_write_b128 v247, v[164:167] offset:64
    s_nop 1
    ds_write_b128 v248, v[168:171] offset:1088
    s_lshr_b32 s13, s7, 1
    s_mul_i32 s24, s13, 49152
    s_add_u32 s24, s24, 65536
    s_and_b32 s61, s7, 1
    ds_write_b64 v249, v[172:173] offset:2112
    ds_write_b64 v249, v[174:175] offset:2240
    s_cmp_ge_u32 s3, 4
    s_cbranch_scc1 k_y
    s_add_u32 m0, s15, 131072
    s_mov_b32 s58, s57
    buffer_load_dwordx4 v240, s[48:51], s58 offen offset:0  lds
    buffer_load_dwordx4 v241, s[48:51], s58 offen offset:1024  lds
    s_add_u32 m0, s15, 139264
    s_add_u32 s57, s57, 229376
    buffer_load_dwordx4 v242, s[52:55], s58 offen offset:0  lds
    buffer_load_dwordx4 v243, s[52:55], s58 offen offset:1024  lds
    s_cmp_eq_u32 s57, 1605632
    s_cselect_b32 s57, 0, s57
    v_mov_b32 v244, 0
    s_lshl_b32 s13, s2, 1
    s_lshr_b32 s58, s7, 1
    s_add_u32 s13, s13, s58
    s_mul_i32 s13, s13, 14
    v_min_u32 v4, 13, v1
    v_add_lshl_u32 v4, v4, s13, 8
    s_bitcmp1_b32 s7, 0
    s_cselect_b32 s58, s34, s32
    s_cselect_b32 s59, s35, s33
    global_load_short_d16_hi v244, v245, s[4:5]
    global_load_dword v0, v4, s[58:59] offset:128
    s_mov_b32 s14, s24
    v_and_b32 v20, 15, v1
    v_lshrrev_b32 v21, 4, v1
    v_or_b32 v24, 1, v20
    v_lshlrev_b32 v25, 3, v21
    v_sub_u32 v24, v25, v24
    v_lshlrev_b32 v24, 1, v24
    v_and_b32 v25, 1, v1
    v_mul_u32_u24 v25, 4160, v25
    v_sub_u32 v24, v24, v25
    v_add_u32 v24, s14, v24
    v_add_u32 v216, 7710, v24
    v_add_u32 v217, 6686, v24
    v_add_u32 v218, 5662, v24
    v_add_u32 v219, 4638, v24
    v_lshlrev_b32 v22, 5, v20
    v_lshl_add_u32 v221, v21, 3, v22
    v_lshl_add_u32 v22, v21, 4, v22
    v_add_u32 v22, s14, v22
    v_add_u32 v220, 8800, v22
    s_mul_i32 s13, s60, 4224
    s_add_u32 s13, s13, 10485760
    v_add_u32 v222, s13, v10
    v_add_u32 v223, s14, v10
    s_and_b32 s13, s2, 7
    s_lshl_b32 s13, s13, 2
    s_add_u32 s13, s13, s8
    s_lshl_b32 s13, s13, 8
    s_lshl_b32 s58, s7, 6
    s_add_u32 s13, s13, s58
    s_add_u32 s13, s13, 16777216
    v_lshlrev_b32 v225, 2, v20
    v_add_u32 v224, s13, v225
    s_add_u32 s58, s58, 130752
    v_add_u32 v225, s58, v225
    s_lshl_b32 s13, s10, 1
    s_and_b32 s58, s13, 3
    s_lshl_b32 s58, s58, 3
    s_lshr_b32 s13, s13, 2
    s_add_u32 s13, s13, s58
    s_lshl_b32 s13, s13, 7
    s_add_u32 s13, s13, 16842752
    v_lshrrev_b32 v226, 1, v1
    v_lshlrev_b32 v226, 12, v226
    v_and_b32 v227, 1, v1
    v_lshl_add_u32 v226, v227, 10, v226
    v_add_u32 v226, s13, v226
    v_mov_b32 v227, 1
    v_add_u32 v6, 98304, v2
    v_add_u32 v4, 114688, v3
    v_xor_b32 v7, 32, v6
    v_xor_b32 v5, 32, v4
    v_xor_b32 v8, 64, v6
    v_xor_b32 v9, 96, v6
    s_waitcnt lgkmcnt(0)
    s_barrier
    s_mov_b32 s30, 0x102543
    s_mov_b32 s31, 0x798798
    s_mov_b32 s43, 7
    s_mov_b32 s59, 7
    s_call_b64 s[100:101], k_pass
    s_add_u32 m0, s15, 114688
    s_add_u32 s58, s57, 128
    buffer_load_dwordx4 v240, s[48:51], s58 offen offset:0  lds
    buffer_load_dwordx4 v241, s[48:51], s58 offen offset:1024  lds
    s_add_u32 m0, s15, 122880
    s_add_u32 s57, s57, 229376
    buffer_load_dwordx4 v242, s[52:55], s58 offen offset:0  lds
    buffer_load_dwordx4 v243, s[52:55], s58 offen offset:1024  lds
    s_cmp_eq_u32 s57, 1605632
    s_cselect_b32 s57, 0, s57
    s_waitcnt lgkmcnt(0)
    v_mov_b32 v48, 0
    v_mov_b32 v49, 0
    v_mov_b32 v50, 0
    v_mov_b32 v51, 0
    v_mov_b32 v52, 0
    v_mov_b32 v53, 0
    v_mov_b32 v54, 0
    v_mov_b32 v55, 0
    v_mov_b32 v56, 0
    v_mov_b32 v57, 0
    v_mov_b32 v58, 0
    v_mov_b32 v59, 0
    v_mov_b32 v60, 0
    v_mov_b32 v61, 0
    v_mov_b32 v62, 0
    v_mov_b32 v63, 0
    s_barrier
    s_add_u32 m0, s15, 131072
    s_add_u32 s58, s57, 128
    buffer_load_dwordx4 v240, s[48:51], s58 offen offset:0  lds
    buffer_load_dwordx4 v241, s[48:51], s58 offen offset:1024  lds
    s_add_u32 m0, s15, 139264
    s_add_u32 s57, s57, 229376
    buffer_load_dwordx4 v242, s[52:55], s58 offen offset:0  lds
    buffer_load_dwordx4 v243, s[52:55], s58 offen offset:1024  lds
    s_cmp_eq_u32 s57, 1605632
    s_cselect_b32 s57, 0, s57
    v_mul_f32 v144, s62, v80
    v_mul_f32 v145, s62, v81
    v_mul_f32 v146, s62, v82
    v_mul_f32 v147, s62, v83
    v_mul_f32 v148, s62, v84
    v_mul_f32 v149, s62, v85
    v_mul_f32 v150, s62, v86
    v_mul_f32 v151, s62, v87
    v_exp_f32 v144, v144
    v_mul_f32 v80, v80, v88
    v_exp_f32 v145, v145
    v_mul_f32 v81, v81, v89
    v_exp_f32 v146, v146
    v_mul_f32 v82, v82, v90
    v_exp_f32 v147, v147
    v_mul_f32 v83, v83, v91
    v_exp_f32 v148, v148
    v_mul_f32 v84, v84, v92
    v_exp_f32 v149, v149
    v_mul_f32 v85, v85, v93
    v_exp_f32 v150, v150
    v_mul_f32 v86, v86, v94
    v_exp_f32 v151, v151
    v_mul_f32 v87, v87, v95
    v_add_f32 v144, 1.0, v144
    v_add_f32 v145, 1.0, v145
    s_add_u32 m0, s15, 98304
    s_add_u32 s58, s57, 128
    buffer_load_dwordx4 v240, s[48:51], s58 offen offset:0  lds
    buffer_load_dwordx4 v241, s[48:51], s58 offen offset:1024  lds
    s_add_u32 m0, s15, 106496
    s_add_u32 s57, s57, 229376
    buffer_load_dwordx4 v242, s[52:55], s58 offen offset:0  lds
    buffer_load_dwordx4 v243, s[52:55], s58 offen offset:1024  lds
    s_cmp_eq_u32 s57, 1605632
    s_cselect_b32 s57, 0, s57
    s_waitcnt vmcnt(8)
    s_barrier
    s_add_u32 m0, s15, 147456
    s_add_u32 s58, s57, 128
    buffer_load_dwordx4 v240, s[48:51], s58 offen offset:0  lds
    buffer_load_dwordx4 v241, s[48:51], s58 offen offset:1024  lds
    s_add_u32 m0, s15, 155648
    s_add_u32 s57, s57, 229376
    buffer_load_dwordx4 v242, s[52:55], s58 offen offset:0  lds
    buffer_load_dwordx4 v243, s[52:55], s58 offen offset:1024  lds
    s_cmp_eq_u32 s57, 1605632
    s_cselect_b32 s57, 0, s57
    v_add_f32 v146, 1.0, v146
    v_add_f32 v147, 1.0, v147
    v_add_f32 v148, 1.0, v148
    v_add_f32 v149, 1.0, v149
    v_add_f32 v150, 1.0, v150
    v_add_f32 v151, 1.0, v151
    v_rcp_f32 v144, v144
    v_rcp_f32 v145, v145
    v_rcp_f32 v146, v146
    v_mul_f32 v80, v80, v144
    v_rcp_f32 v147, v147
    v_mul_f32 v81, v81, v145
    v_rcp_f32 v148, v148
    v_mul_f32 v82, v82, v146
    v_rcp_f32 v149, v149
    v_mul_f32 v83, v83, v147
    v_rcp_f32 v150, v150
    v_mul_f32 v84, v84, v148
    v_rcp_f32 v151, v151
    v_mul_f32 v85, v85, v149
    v_mul_f32 v86, v86, v150
    v_mul_f32 v87, v87, v151
    v_cvt_pk_bf16_f32 v88, v80, v81
    v_cvt_pk_bf16_f32 v89, v82, v83
    v_cvt_pk_bf16_f32 v90, v84, v85
    v_cvt_pk_bf16_f32 v91, v86, v87
    s_add_u32 m0, s15, 49152
    s_add_u32 s58, s57, 128
    buffer_load_dwordx4 v240, s[48:51], s58 offen offset:0  lds
    buffer_load_dwordx4 v241, s[48:51], s58 offen offset:1024  lds
    s_add_u32 m0, s15, 57344
    s_add_u32 s57, s57, 229376
    buffer_load_dwordx4 v242, s[52:55], s58 offen offset:0  lds
    buffer_load_dwordx4 v243, s[52:55], s58 offen offset:1024  lds
    s_cmp_eq_u32 s57, 1605632
    s_cselect_b32 s57, 0, s57
    s_waitcnt vmcnt(12)
    s_barrier
    global_store_dwordx4 v14, v[88:91], s[40:41] offset:0 sc1
    v_mul_f32 v152, s62, v96
    v_mul_f32 v153, s62, v97
    v_mul_f32 v154, s62, v98
    v_mul_f32 v155, s62, v99
    v_mul_f32 v156, s62, v100
    v_mul_f32 v157, s62, v101
    v_mul_f32 v158, s62, v102
    v_mul_f32 v159, s62, v103
    v_exp_f32 v152, v152
    v_mul_f32 v96, v96, v104
    v_exp_f32 v153, v153
    v_mul_f32 v97, v97, v105
    v_exp_f32 v154, v154
    v_mul_f32 v98, v98, v106
    v_exp_f32 v155, v155
    v_mul_f32 v99, v99, v107
    v_exp_f32 v156, v156
    v_mul_f32 v100, v100, v108
    v_exp_f32 v157, v157
    v_mul_f32 v101, v101, v109
    v_exp_f32 v158, v158
    v_mul_f32 v102, v102, v110
    v_exp_f32 v159, v159
    v_mul_f32 v103, v103, v111
    v_add_f32 v152, 1.0, v152
    v_add_f32 v153, 1.0, v153
    v_add_f32 v154, 1.0, v154
    v_add_f32 v155, 1.0, v155
    v_add_f32 v156, 1.0, v156
    v_add_f32 v157, 1.0, v157
    v_add_f32 v158, 1.0, v158
    v_add_f32 v159, 1.0, v159
    v_rcp_f32 v152, v152
    v_rcp_f32 v153, v153
    v_rcp_f32 v154, v154
    v_mul_f32 v96, v96, v152
    v_rcp_f32 v155, v155
    v_mul_f32 v97, v97, v153
    v_rcp_f32 v156, v156
    v_mul_f32 v98, v98, v154
    v_rcp_f32 v157, v157
    v_mul_f32 v99, v99, v155
    v_rcp_f32 v158, v158
    v_mul_f32 v100, v100, v156
    v_rcp_f32 v159, v159
    v_mul_f32 v101, v101, v157
    v_mul_f32 v102, v102, v158
    v_mov_b32 v40, 81600
    ds_write_b128 v40, v[48:51]
    ds_write_b128 v40, v[48:51] offset:16
    s_waitcnt vmcnt(1) lgkmcnt(0)
    s_barrier
    s_setprio 2
    v_mul_f32 v103, v103, v159
    v_cvt_pk_bf16_f32 v104, v96, v97
    v_cvt_pk_bf16_f32 v105, v98, v99
    v_cvt_pk_bf16_f32 v106, v100, v101
    v_cvt_pk_bf16_f32 v107, v102, v103
    global_store_dwordx4 v14, v[104:107], s[40:41] offset:2048 sc1
    v_mul_f32 v144, s62, v112
    v_mul_f32 v145, s62, v113
    v_mul_f32 v146, s62, v114
    v_mul_f32 v147, s62, v115
    v_mul_f32 v148, s62, v116
    v_mul_f32 v149, s62, v117
    v_mul_f32 v150, s62, v118
    v_mul_f32 v151, s62, v119
    v_exp_f32 v144, v144
    v_mul_f32 v112, v112, v120
    v_exp_f32 v145, v145
    v_mul_f32 v113, v113, v121
    v_exp_f32 v146, v146
    v_mul_f32 v114, v114, v122
    v_exp_f32 v147, v147
    v_mul_f32 v115, v115, v123
    v_exp_f32 v148, v148
    v_mul_f32 v116, v116, v124
    v_exp_f32 v149, v149
    v_mul_f32 v117, v117, v125
    v_exp_f32 v150, v150
    v_mul_f32 v118, v118, v126
    v_exp_f32 v151, v151
    v_mul_f32 v119, v119, v127
    v_add_f32 v144, 1.0, v144
    v_add_f32 v145, 1.0, v145
    v_add_f32 v146, 1.0, v146
    v_add_f32 v147, 1.0, v147
    v_add_f32 v148, 1.0, v148
    v_add_f32 v149, 1.0, v149
    v_add_f32 v150, 1.0, v150
    v_add_f32 v151, 1.0, v151
    v_rcp_f32 v144, v144
    v_rcp_f32 v145, v145
    v_rcp_f32 v146, v146
    v_mul_f32 v112, v112, v144
    v_rcp_f32 v147, v147
    v_mul_f32 v113, v113, v145
    v_rcp_f32 v148, v148
    v_mul_f32 v114, v114, v146
    v_rcp_f32 v149, v149
    v_mul_f32 v115, v115, v147
    v_rcp_f32 v150, v150
    v_mul_f32 v116, v116, v148
    v_rcp_f32 v151, v151
    v_mul_f32 v117, v117, v149
    v_mul_f32 v118, v118, v150
    v_mul_f32 v119, v119, v151
    v_cvt_pk_bf16_f32 v120, v112, v113
    v_cvt_pk_bf16_f32 v121, v114, v115
    v_cvt_pk_bf16_f32 v122, v116, v117
    v_cvt_pk_bf16_f32 v123, v118, v119
    global_store_dwordx4 v14, v[120:123], s[40:41] offset:512 sc1
    v_mul_f32 v152, s62, v128
    v_mul_f32 v153, s62, v129
    v_mul_f32 v154, s62, v130
    v_mul_f32 v155, s62, v131
    v_mul_f32 v156, s62, v132
    v_mul_f32 v157, s62, v133
    v_mul_f32 v158, s62, v134
    v_mul_f32 v159, s62, v135
    v_exp_f32 v152, v152
    v_mul_f32 v128, v128, v136
    v_exp_f32 v153, v153
    v_mul_f32 v129, v129, v137
    v_exp_f32 v154, v154
    v_mul_f32 v130, v130, v138
    v_exp_f32 v155, v155
    v_mul_f32 v131, v131, v139
    v_exp_f32 v156, v156
    v_mul_f32 v132, v132, v140
    v_exp_f32 v157, v157
    v_mul_f32 v133, v133, v141
    v_exp_f32 v158, v158
    v_mul_f32 v134, v134, v142
    v_exp_f32 v159, v159
    s_load_dword s27, s[28:29], 0 glc
    v_mul_f32 v135, v135, v143
    v_add_f32 v152, 1.0, v152
    v_add_f32 v153, 1.0, v153
    v_add_f32 v154, 1.0, v154
    v_add_f32 v155, 1.0, v155
    v_add_f32 v156, 1.0, v156
    v_add_f32 v157, 1.0, v157
    v_add_f32 v158, 1.0, v158
    v_add_f32 v159, 1.0, v159
    v_rcp_f32 v152, v152
    v_rcp_f32 v153, v153
    v_rcp_f32 v154, v154
    v_mul_f32 v128, v128, v152
    v_rcp_f32 v155, v155
    v_mul_f32 v129, v129, v153
    v_rcp_f32 v156, v156
    v_mul_f32 v130, v130, v154
    v_rcp_f32 v157, v157
    v_mul_f32 v131, v131, v155
    v_rcp_f32 v158, v158
    v_mul_f32 v132, v132, v156
    v_rcp_f32 v159, v159
    v_mul_f32 v133, v133, v157
    v_mul_f32 v134, v134, v158
    v_mul_f32 v135, v135, v159
    v_cvt_pk_bf16_f32 v136, v128, v129
    v_cvt_pk_bf16_f32 v137, v130, v131
    v_cvt_pk_bf16_f32 v138, v132, v133
    v_cvt_pk_bf16_f32 v139, v134, v135
    global_store_dwordx4 v14, v[136:139], s[40:41] offset:2560 sc1
    s_waitcnt lgkmcnt(0)
    s_cmp_eq_u32 s27, 32
    s_cbranch_scc0 k_u0
    global_load_dwordx4 v[16:19], v222, s[40:41] offset:0 sc1
    global_load_dwordx4 v[20:23], v222, s[40:41] offset:1024 sc1
    global_load_dwordx4 v[24:27], v222, s[40:41] offset:2048 sc1
    global_load_dwordx4 v[28:31], v222, s[40:41] offset:3072 sc1
    global_load_dword v15, v224, s[40:41] sc1
    s_waitcnt vmcnt(5)
    s_branch k_u1
k_u0:
    s_waitcnt vmcnt(0)
k_u1:
    v_mov_b32 v42, 81608
    v_mov_b32 v43, 1
    s_mov_b64 exec, 1
    ds_add_rtn_u32 v44, v42, v43
    s_waitcnt lgkmcnt(0)
    v_readfirstlane_b32 s58, v44
    s_mov_b64 exec, -1
    s_cmp_eq_u32 s58, 3
    s_cbranch_scc0 k_s2
    s_lshl_b32 s13, s10, 1
    s_and_b32 s58, s13, 3
    s_lshl_b32 s58, s58, 3
    s_lshr_b32 s13, s13, 2
    s_add_u32 s13, s13, s58
    s_lshl_b32 s13, s13, 7
    s_add_u32 s13, s13, 16842752
    s_add_u32 s44, s40, s13
    s_addc_u32 s45, s41, 0
    s_mov_b32 s46, 1
    s_atomic_add s46, s[44:45], 4
    s_atomic_add s46, s[44:45], 1028
    s_atomic_add s46, s[44:45], 4100
    s_atomic_add s46, s[44:45], 5124
    s_atomic_add s46, s[44:45], 8196
    s_atomic_add s46, s[44:45], 9220
    s_atomic_add s46, s[44:45], 12292
    s_atomic_add s46, s[44:45], 13316
    s_atomic_add s46, s[44:45], 16388
    s_atomic_add s46, s[44:45], 17412
    s_atomic_add s46, s[44:45], 20484
    s_atomic_add s46, s[44:45], 21508
    s_atomic_add s46, s[44:45], 24580
    s_atomic_add s46, s[44:45], 25604
k_s2:
    s_cmp_eq_u32 s27, 32
    s_cbranch_scc1 k_u2
    s_mov_b32 s59, 0
k_c1_l:
    s_waitcnt lgkmcnt(0)
    s_cmp_eq_u32 s27, 32
    s_cbranch_scc1 k_c1_d
    s_add_u32 s59, s59, 1
    s_sleep 1
    s_cmp_lt_u32 s59, 256
    s_cbranch_scc0 k_c1_v
    s_load_dword s27, s[28:29], 0 glc
    s_branch k_c1_l
k_c1_v:
    v_mov_b32 v13, 0
    global_load_dword v13, v13, s[28:29] offset:0 sc1
    s_waitcnt vmcnt(0)
    v_readfirstlane_b32 s27, v13
    s_cmp_lt_u32 s59, 40000
    s_cbranch_scc1 k_c1_l
k_c1_d:
    global_load_dwordx4 v[16:19], v222, s[40:41] offset:0 sc1
    global_load_dwordx4 v[20:23], v222, s[40:41] offset:1024 sc1
    global_load_dwordx4 v[24:27], v222, s[40:41] offset:2048 sc1
    global_load_dwordx4 v[28:31], v222, s[40:41] offset:3072 sc1
    global_load_dword v15, v224, s[40:41] sc1
k_u2:
    ds_read_b32 v41, v40
    s_waitcnt vmcnt(0)
    ds_write_b128 v223, v[16:19] offset:8832
    ds_write_b128 v223, v[20:23] offset:9856
    ds_write_b128 v223, v[24:27] offset:10880
    ds_write_b128 v223, v[28:31] offset:11904
    ds_write_b32 v225, v15
    s_mov_b32 s59, 40000
k_ps:
    s_waitcnt lgkmcnt(0)
    v_readfirstlane_b32 s58, v41
    s_nop 0
    s_cmp_eq_u32 s58, 4
    s_cbranch_scc1 k_psd
    ds_read_b32 v41, v40
    s_sub_u32 s59, s59, 1
    s_cmp_lg_u32 s59, 0
    s_cbranch_scc1 k_ps
k_psd:
    s_setprio 0
    s_cmp_eq_u32 s61, 0
    s_cbranch_scc0 k_set1
    ds_read_b128 v[120:123], v220 offset:0
    ds_read2_b32 v[88:89], v216 offset0:128 offset1:129
    ds_read2_b32 v[90:91], v216 offset0:130 offset1:131
    ds_read_b128 v[124:127], v220 offset:512
    ds_read2_b32 v[92:93], v216 offset0:0 offset1:1
    ds_read2_b32 v[94:95], v216 offset0:2 offset1:3
    ds_read_b128 v[128:131], v220 offset:1024
    ds_read2_b32 v[96:97], v217 offset0:128 offset1:129
    ds_read2_b32 v[98:99], v217 offset0:130 offset1:131
    ds_read_b128 v[132:135], v220 offset:1536
    ds_read2_b32 v[100:101], v217 offset0:0 offset1:1
    ds_read2_b32 v[102:103], v217 offset0:2 offset1:3
    ds_read_b128 v[136:139], v220 offset:2048
    ds_read2_b32 v[104:105], v218 offset0:128 offset1:129
    ds_read2_b32 v[106:107], v218 offset0:130 offset1:131
    ds_read_b128 v[140:143], v220 offset:2560
    ds_read2_b32 v[108:109], v218 offset0:0 offset1:1
    ds_read2_b32 v[110:111], v218 offset0:2 offset1:3
    ds_read_b128 v[144:147], v220 offset:3072
    ds_read2_b32 v[112:113], v219 offset0:128 offset1:129
    ds_read2_b32 v[114:115], v219 offset0:130 offset1:131
    ds_read_b128 v[148:151], v220 offset:3584
    ds_read2_b32 v[116:117], v219 offset0:0 offset1:1
    ds_read2_b32 v[118:119], v219 offset0:2 offset1:3
    v_subrev_u32 v216, 64, v216
    v_subrev_u32 v217, 64, v217
    v_subrev_u32 v218, 64, v218
    v_subrev_u32 v219, 64, v219
    v_subrev_u32 v220, 64, v220
    s_mov_b32 s21, 4
k_cl0:
    s_waitcnt lgkmcnt(0)
    v_mfma_f32_16x16x32_bf16 v[60:63], v[88:91], v[148:151], v[60:63]
    ds_read_b128 v[184:187], v220 offset:0
    ds_read2_b32 v[152:153], v216 offset0:128 offset1:129
    v_mfma_f32_16x16x32_bf16 v[56:59], v[88:91], v[136:139], v[56:59]
    ds_read2_b32 v[154:155], v216 offset0:130 offset1:131
    ds_read_b128 v[188:191], v220 offset:512
    v_mfma_f32_16x16x32_bf16 v[52:55], v[88:91], v[132:135], v[52:55]
    ds_read2_b32 v[156:157], v216 offset0:0 offset1:1
    ds_read2_b32 v[158:159], v216 offset0:2 offset1:3
    v_mfma_f32_16x16x32_bf16 v[48:51], v[88:91], v[120:123], v[48:51]
    ds_read_b128 v[192:195], v220 offset:1024
    ds_read2_b32 v[160:161], v217 offset0:128 offset1:129
    v_mfma_f32_16x16x32_bf16 v[60:63], v[92:95], v[144:147], v[60:63]
    ds_read2_b32 v[162:163], v217 offset0:130 offset1:131
    ds_read_b128 v[196:199], v220 offset:1536
    v_mfma_f32_16x16x32_bf16 v[56:59], v[92:95], v[132:135], v[56:59]
    ds_read2_b32 v[164:165], v217 offset0:0 offset1:1
    ds_read2_b32 v[166:167], v217 offset0:2 offset1:3
    v_mfma_f32_16x16x32_bf16 v[52:55], v[92:95], v[128:131], v[52:55]
    ds_read_b128 v[200:203], v220 offset:2048
    ds_read2_b32 v[168:169], v218 offset0:128 offset1:129
    v_mfma_f32_16x16x32_bf16 v[60:63], v[96:99], v[140:143], v[60:63]
    ds_read2_b32 v[170:171], v218 offset0:130 offset1:131
    ds_read_b128 v[204:207], v220 offset:2560
    v_mfma_f32_16x16x32_bf16 v[56:59], v[96:99], v[128:131], v[56:59]
    ds_read2_b32 v[172:173], v218 offset0:0 offset1:1
    ds_read2_b32 v[174:175], v218 offset0:2 offset1:3
    v_mfma_f32_16x16x32_bf16 v[52:55], v[96:99], v[124:127], v[52:55]
    ds_read_b128 v[208:211], v220 offset:3072
    ds_read2_b32 v[176:177], v219 offset0:128 offset1:129
    v_mfma_f32_16x16x32_bf16 v[60:63], v[100:103], v[136:139], v[60:63]
    ds_read2_b32 v[178:179], v219 offset0:130 offset1:131
    ds_read_b128 v[212:215], v220 offset:3584
    v_mfma_f32_16x16x32_bf16 v[56:59], v[100:103], v[124:127], v[56:59]
    ds_read2_b32 v[180:181], v219 offset0:0 offset1:1
    ds_read2_b32 v[182:183], v219 offset0:2 offset1:3
    v_mfma_f32_16x16x32_bf16 v[52:55], v[100:103], v[120:123], v[52:55]
    v_subrev_u32 v216, 64, v216
    v_subrev_u32 v217, 64, v217
    v_mfma_f32_16x16x32_bf16 v[60:63], v[104:107], v[132:135], v[60:63]
    v_subrev_u32 v218, 64, v218
    v_subrev_u32 v219, 64, v219
    v_mfma_f32_16x16x32_bf16 v[56:59], v[104:107], v[120:123], v[56:59]
    v_subrev_u32 v220, 64, v220
    v_mfma_f32_16x16x32_bf16 v[60:63], v[108:111], v[128:131], v[60:63]
    v_mfma_f32_16x16x32_bf16 v[60:63], v[112:115], v[124:127], v[60:63]
    v_mfma_f32_16x16x32_bf16 v[60:63], v[116:119], v[120:123], v[60:63]
    s_waitcnt lgkmcnt(0)
    v_mfma_f32_16x16x32_bf16 v[60:63], v[152:155], v[212:215], v[60:63]
    ds_read_b128 v[120:123], v220 offset:0
    ds_read2_b32 v[88:89], v216 offset0:128 offset1:129
    v_mfma_f32_16x16x32_bf16 v[56:59], v[152:155], v[200:203], v[56:59]
    ds_read2_b32 v[90:91], v216 offset0:130 offset1:131
    ds_read_b128 v[124:127], v220 offset:512
    v_mfma_f32_16x16x32_bf16 v[52:55], v[152:155], v[196:199], v[52:55]
    ds_read2_b32 v[92:93], v216 offset0:0 offset1:1
    ds_read2_b32 v[94:95], v216 offset0:2 offset1:3
    v_mfma_f32_16x16x32_bf16 v[48:51], v[152:155], v[184:187], v[48:51]
    ds_read_b128 v[128:131], v220 offset:1024
    ds_read2_b32 v[96:97], v217 offset0:128 offset1:129
    v_mfma_f32_16x16x32_bf16 v[60:63], v[156:159], v[208:211], v[60:63]
    ds_read2_b32 v[98:99], v217 offset0:130 offset1:131
    ds_read_b128 v[132:135], v220 offset:1536
    v_mfma_f32_16x16x32_bf16 v[56:59], v[156:159], v[196:199], v[56:59]
    ds_read2_b32 v[100:101], v217 offset0:0 offset1:1
    ds_read2_b32 v[102:103], v217 offset0:2 offset1:3
    v_mfma_f32_16x16x32_bf16 v[52:55], v[156:159], v[192:195], v[52:55]
    ds_read_b128 v[136:139], v220 offset:2048
    ds_read2_b32 v[104:105], v218 offset0:128 offset1:129
    v_mfma_f32_16x16x32_bf16 v[60:63], v[160:163], v[204:207], v[60:63]
    ds_read2_b32 v[106:107], v218 offset0:130 offset1:131
    ds_read_b128 v[140:143], v220 offset:2560
    v_mfma_f32_16x16x32_bf16 v[56:59], v[160:163], v[192:195], v[56:59]
    ds_read2_b32 v[108:109], v218 offset0:0 offset1:1
    ds_read2_b32 v[110:111], v218 offset0:2 offset1:3
    v_mfma_f32_16x16x32_bf16 v[52:55], v[160:163], v[188:191], v[52:55]
    ds_read_b128 v[144:147], v220 offset:3072
    ds_read2_b32 v[112:113], v219 offset0:128 offset1:129
    v_mfma_f32_16x16x32_bf16 v[60:63], v[164:167], v[200:203], v[60:63]
    ds_read2_b32 v[114:115], v219 offset0:130 offset1:131
    ds_read_b128 v[148:151], v220 offset:3584
    v_mfma_f32_16x16x32_bf16 v[56:59], v[164:167], v[188:191], v[56:59]
    ds_read2_b32 v[116:117], v219 offset0:0 offset1:1
    ds_read2_b32 v[118:119], v219 offset0:2 offset1:3
    v_mfma_f32_16x16x32_bf16 v[52:55], v[164:167], v[184:187], v[52:55]
    v_subrev_u32 v216, 64, v216
    v_subrev_u32 v217, 64, v217
    v_mfma_f32_16x16x32_bf16 v[60:63], v[168:171], v[196:199], v[60:63]
    v_subrev_u32 v218, 64, v218
    v_subrev_u32 v219, 64, v219
    v_mfma_f32_16x16x32_bf16 v[56:59], v[168:171], v[184:187], v[56:59]
    v_subrev_u32 v220, 64, v220
    v_mfma_f32_16x16x32_bf16 v[60:63], v[172:175], v[192:195], v[60:63]
    v_mfma_f32_16x16x32_bf16 v[60:63], v[176:179], v[188:191], v[60:63]
    v_mfma_f32_16x16x32_bf16 v[60:63], v[180:183], v[184:187], v[60:63]
    s_sub_u32 s21, s21, 1
    s_cmp_lg_u32 s21, 0
    s_cbranch_scc1 k_cl0
    v_add_u32 v26, s14, v221
    ds_read_b64 v[32:33], v26 offset:8832
    ds_read_b64 v[34:35], v26 offset:10368
    ds_read_b64 v[36:37], v26 offset:10880
    ds_read_b64 v[38:39], v26 offset:12416
    s_mul_i32 s15, s60, 4224
    s_add_u32 s15, s15, 14680064
    v_add_u32 v27, s15, v221
    s_waitcnt lgkmcnt(0)
    v_lshlrev_b32 v40, 16, v32
    v_and_b32 v41, 0xffff0000, v32
    v_lshlrev_b32 v42, 16, v33
    v_and_b32 v43, 0xffff0000, v33
    v_fmac_f32 v48, v40, v244
    v_fmac_f32 v49, v41, v244
    v_fmac_f32 v50, v42, v244
    v_fmac_f32 v51, v43, v244
    v_cvt_pk_bf16_f32 v48, v48, v49
    v_cvt_pk_bf16_f32 v49, v50, v51
    global_store_dwordx2 v27, v[48:49], s[40:41] offset:0 sc1
    v_lshlrev_b32 v40, 16, v34
    v_and_b32 v41, 0xffff0000, v34
    v_lshlrev_b32 v42, 16, v35
    v_and_b32 v43, 0xffff0000, v35
    v_fmac_f32 v52, v40, v244
    v_fmac_f32 v53, v41, v244
    v_fmac_f32 v54, v42, v244
    v_fmac_f32 v55, v43, v244
    v_cvt_pk_bf16_f32 v52, v52, v53
    v_cvt_pk_bf16_f32 v53, v54, v55
    global_store_dwordx2 v27, v[52:53], s[40:41] offset:1536 sc1
    v_lshlrev_b32 v40, 16, v36
    v_and_b32 v41, 0xffff0000, v36
    v_lshlrev_b32 v42, 16, v37
    v_and_b32 v43, 0xffff0000, v37
    v_fmac_f32 v56, v40, v244
    v_fmac_f32 v57, v41, v244
    v_fmac_f32 v58, v42, v244
    v_fmac_f32 v59, v43, v244
    v_cvt_pk_bf16_f32 v56, v56, v57
    v_cvt_pk_bf16_f32 v57, v58, v59
    global_store_dwordx2 v27, v[56:57], s[40:41] offset:2048 sc1
    v_lshlrev_b32 v40, 16, v38
    v_and_b32 v41, 0xffff0000, v38
    v_lshlrev_b32 v42, 16, v39
    v_and_b32 v43, 0xffff0000, v39
    v_fmac_f32 v60, v40, v244
    v_fmac_f32 v61, v41, v244
    v_fmac_f32 v62, v42, v244
    v_fmac_f32 v63, v43, v244
    v_cvt_pk_bf16_f32 v60, v60, v61
    v_cvt_pk_bf16_f32 v61, v62, v63
    global_store_dwordx2 v27, v[60:61], s[40:41] offset:3584 sc1
    s_branch k_pub
k_set1:
    ds_read_b128 v[120:123], v220 offset:0
    ds_read2_b32 v[88:89], v216 offset0:128 offset1:129
    ds_read2_b32 v[90:91], v216 offset0:130 offset1:131
    ds_read_b128 v[124:127], v220 offset:512
    ds_read2_b32 v[92:93], v216 offset0:0 offset1:1
    ds_read2_b32 v[94:95], v216 offset0:2 offset1:3
    ds_read_b128 v[128:131], v220 offset:1024
    ds_read2_b32 v[96:97], v217 offset0:128 offset1:129
    ds_read2_b32 v[98:99], v217 offset0:130 offset1:131
    ds_read_b128 v[132:135], v220 offset:1536
    ds_read2_b32 v[100:101], v217 offset0:0 offset1:1
    ds_read2_b32 v[102:103], v217 offset0:2 offset1:3
    ds_read_b128 v[136:139], v220 offset:2048
    ds_read2_b32 v[104:105], v218 offset0:128 offset1:129
    ds_read2_b32 v[106:107], v218 offset0:130 offset1:131
    ds_read_b128 v[140:143], v220 offset:2560
    ds_read2_b32 v[108:109], v218 offset0:0 offset1:1
    ds_read2_b32 v[110:111], v218 offset0:2 offset1:3
    ds_read_b128 v[144:147], v220 offset:3072
    ds_read2_b32 v[112:113], v219 offset0:128 offset1:129
    ds_read2_b32 v[114:115], v219 offset0:130 offset1:131
    v_subrev_u32 v216, 64, v216
    v_subrev_u32 v217, 64, v217
    v_subrev_u32 v218, 64, v218
    v_subrev_u32 v219, 64, v219
    v_subrev_u32 v220, 64, v220
    s_mov_b32 s21, 4
k_cl1:
    s_waitcnt lgkmcnt(0)
    v_mfma_f32_16x16x32_bf16 v[60:63], v[88:91], v[144:147], v[60:63]
    ds_read_b128 v[184:187], v220 offset:0
    ds_read2_b32 v[152:153], v216 offset0:128 offset1:129
    v_mfma_f32_16x16x32_bf16 v[56:59], v[88:91], v[140:143], v[56:59]
    ds_read2_b32 v[154:155], v216 offset0:130 offset1:131
    ds_read_b128 v[188:191], v220 offset:512
    v_mfma_f32_16x16x32_bf16 v[52:55], v[88:91], v[128:131], v[52:55]
    ds_read2_b32 v[156:157], v216 offset0:0 offset1:1
    ds_read2_b32 v[158:159], v216 offset0:2 offset1:3
    v_mfma_f32_16x16x32_bf16 v[48:51], v[88:91], v[124:127], v[48:51]
    ds_read_b128 v[192:195], v220 offset:1024
    ds_read2_b32 v[160:161], v217 offset0:128 offset1:129
    v_mfma_f32_16x16x32_bf16 v[60:63], v[92:95], v[140:143], v[60:63]
    ds_read2_b32 v[162:163], v217 offset0:130 offset1:131
    ds_read_b128 v[196:199], v220 offset:1536
    v_mfma_f32_16x16x32_bf16 v[56:59], v[92:95], v[136:139], v[56:59]
    ds_read2_b32 v[164:165], v217 offset0:0 offset1:1
    ds_read2_b32 v[166:167], v217 offset0:2 offset1:3
    v_mfma_f32_16x16x32_bf16 v[52:55], v[92:95], v[124:127], v[52:55]
    ds_read_b128 v[200:203], v220 offset:2048
    ds_read2_b32 v[168:169], v218 offset0:128 offset1:129
    v_mfma_f32_16x16x32_bf16 v[48:51], v[92:95], v[120:123], v[48:51]
    ds_read2_b32 v[170:171], v218 offset0:130 offset1:131
    ds_read_b128 v[204:207], v220 offset:2560
    v_mfma_f32_16x16x32_bf16 v[60:63], v[96:99], v[136:139], v[60:63]
    ds_read2_b32 v[172:173], v218 offset0:0 offset1:1
    ds_read2_b32 v[174:175], v218 offset0:2 offset1:3
    v_mfma_f32_16x16x32_bf16 v[56:59], v[96:99], v[132:135], v[56:59]
    ds_read_b128 v[208:211], v220 offset:3072
    ds_read2_b32 v[176:177], v219 offset0:128 offset1:129
    v_mfma_f32_16x16x32_bf16 v[52:55], v[96:99], v[120:123], v[52:55]
    ds_read2_b32 v[178:179], v219 offset0:130 offset1:131
    v_subrev_u32 v216, 64, v216
    v_mfma_f32_16x16x32_bf16 v[60:63], v[100:103], v[132:135], v[60:63]
    v_subrev_u32 v217, 64, v217
    v_subrev_u32 v218, 64, v218
    v_mfma_f32_16x16x32_bf16 v[56:59], v[100:103], v[128:131], v[56:59]
    v_subrev_u32 v219, 64, v219
    v_subrev_u32 v220, 64, v220
    v_mfma_f32_16x16x32_bf16 v[60:63], v[104:107], v[128:131], v[60:63]
    v_mfma_f32_16x16x32_bf16 v[56:59], v[104:107], v[124:127], v[56:59]
    v_mfma_f32_16x16x32_bf16 v[60:63], v[108:111], v[124:127], v[60:63]
    v_mfma_f32_16x16x32_bf16 v[56:59], v[108:111], v[120:123], v[56:59]
    v_mfma_f32_16x16x32_bf16 v[60:63], v[112:115], v[120:123], v[60:63]
    s_waitcnt lgkmcnt(0)
    v_mfma_f32_16x16x32_bf16 v[60:63], v[152:155], v[208:211], v[60:63]
    ds_read_b128 v[120:123], v220 offset:0
    ds_read2_b32 v[88:89], v216 offset0:128 offset1:129
    v_mfma_f32_16x16x32_bf16 v[56:59], v[152:155], v[204:207], v[56:59]
    ds_read2_b32 v[90:91], v216 offset0:130 offset1:131
    ds_read_b128 v[124:127], v220 offset:512
    v_mfma_f32_16x16x32_bf16 v[52:55], v[152:155], v[192:195], v[52:55]
    ds_read2_b32 v[92:93], v216 offset0:0 offset1:1
    ds_read2_b32 v[94:95], v216 offset0:2 offset1:3
    v_mfma_f32_16x16x32_bf16 v[48:51], v[152:155], v[188:191], v[48:51]
    ds_read_b128 v[128:131], v220 offset:1024
    ds_read2_b32 v[96:97], v217 offset0:128 offset1:129
    v_mfma_f32_16x16x32_bf16 v[60:63], v[156:159], v[204:207], v[60:63]
    ds_read2_b32 v[98:99], v217 offset0:130 offset1:131
    ds_read_b128 v[132:135], v220 offset:1536
    v_mfma_f32_16x16x32_bf16 v[56:59], v[156:159], v[200:203], v[56:59]
    ds_read2_b32 v[100:101], v217 offset0:0 offset1:1
    ds_read2_b32 v[102:103], v217 offset0:2 offset1:3
    v_mfma_f32_16x16x32_bf16 v[52:55], v[156:159], v[188:191], v[52:55]
    ds_read_b128 v[136:139], v220 offset:2048
    ds_read2_b32 v[104:105], v218 offset0:128 offset1:129
    v_mfma_f32_16x16x32_bf16 v[48:51], v[156:159], v[184:187], v[48:51]
    ds_read2_b32 v[106:107], v218 offset0:130 offset1:131
    ds_read_b128 v[140:143], v220 offset:2560
    v_mfma_f32_16x16x32_bf16 v[60:63], v[160:163], v[200:203], v[60:63]
    ds_read2_b32 v[108:109], v218 offset0:0 offset1:1
    ds_read2_b32 v[110:111], v218 offset0:2 offset1:3
    v_mfma_f32_16x16x32_bf16 v[56:59], v[160:163], v[196:199], v[56:59]
    ds_read_b128 v[144:147], v220 offset:3072
    ds_read2_b32 v[112:113], v219 offset0:128 offset1:129
    v_mfma_f32_16x16x32_bf16 v[52:55], v[160:163], v[184:187], v[52:55]
    ds_read2_b32 v[114:115], v219 offset0:130 offset1:131
    v_subrev_u32 v216, 64, v216
    v_mfma_f32_16x16x32_bf16 v[60:63], v[164:167], v[196:199], v[60:63]
    v_subrev_u32 v217, 64, v217
    v_subrev_u32 v218, 64, v218
    v_mfma_f32_16x16x32_bf16 v[56:59], v[164:167], v[192:195], v[56:59]
    v_subrev_u32 v219, 64, v219
    v_subrev_u32 v220, 64, v220
    v_mfma_f32_16x16x32_bf16 v[60:63], v[168:171], v[192:195], v[60:63]
    v_mfma_f32_16x16x32_bf16 v[56:59], v[168:171], v[188:191], v[56:59]
    v_mfma_f32_16x16x32_bf16 v[60:63], v[172:175], v[188:191], v[60:63]
    v_mfma_f32_16x16x32_bf16 v[56:59], v[172:175], v[184:187], v[56:59]
    v_mfma_f32_16x16x32_bf16 v[60:63], v[176:179], v[184:187], v[60:63]
    s_sub_u32 s21, s21, 1
    s_cmp_lg_u32 s21, 0
    s_cbranch_scc1 k_cl1
    v_add_u32 v26, s14, v221
    ds_read_b64 v[32:33], v26 offset:9344
    ds_read_b64 v[34:35], v26 offset:9856
    ds_read_b64 v[36:37], v26 offset:11392
    ds_read_b64 v[38:39], v26 offset:11904
    s_mul_i32 s15, s60, 4224
    s_add_u32 s15, s15, 14680064
    v_add_u32 v27, s15, v221
    s_waitcnt lgkmcnt(0)
    v_lshlrev_b32 v40, 16, v32
    v_and_b32 v41, 0xffff0000, v32
    v_lshlrev_b32 v42, 16, v33
    v_and_b32 v43, 0xffff0000, v33
    v_fmac_f32 v48, v40, v244
    v_fmac_f32 v49, v41, v244
    v_fmac_f32 v50, v42, v244
    v_fmac_f32 v51, v43, v244
    v_cvt_pk_bf16_f32 v48, v48, v49
    v_cvt_pk_bf16_f32 v49, v50, v51
    global_store_dwordx2 v27, v[48:49], s[40:41] offset:512 sc1
    v_lshlrev_b32 v40, 16, v34
    v_and_b32 v41, 0xffff0000, v34
    v_lshlrev_b32 v42, 16, v35
    v_and_b32 v43, 0xffff0000, v35
    v_fmac_f32 v52, v40, v244
    v_fmac_f32 v53, v41, v244
    v_fmac_f32 v54, v42, v244
    v_fmac_f32 v55, v43, v244
    v_cvt_pk_bf16_f32 v52, v52, v53
    v_cvt_pk_bf16_f32 v53, v54, v55
    global_store_dwordx2 v27, v[52:53], s[40:41] offset:1024 sc1
    v_lshlrev_b32 v40, 16, v36
    v_and_b32 v41, 0xffff0000, v36
    v_lshlrev_b32 v42, 16, v37
    v_and_b32 v43, 0xffff0000, v37
    v_fmac_f32 v56, v40, v244
    v_fmac_f32 v57, v41, v244
    v_fmac_f32 v58, v42, v244
    v_fmac_f32 v59, v43, v244
    v_cvt_pk_bf16_f32 v56, v56, v57
    v_cvt_pk_bf16_f32 v57, v58, v59
    global_store_dwordx2 v27, v[56:57], s[40:41] offset:2560 sc1
    v_lshlrev_b32 v40, 16, v38
    v_and_b32 v41, 0xffff0000, v38
    v_lshlrev_b32 v42, 16, v39
    v_and_b32 v43, 0xffff0000, v39
    v_fmac_f32 v60, v40, v244
    v_fmac_f32 v61, v41, v244
    v_fmac_f32 v62, v42, v244
    v_fmac_f32 v63, v43, v244
    v_cvt_pk_bf16_f32 v60, v60, v61
    v_cvt_pk_bf16_f32 v61, v62, v63
    global_store_dwordx2 v27, v[60:61], s[40:41] offset:3072 sc1
k_pub:
    s_setprio 0
    s_lshr_b32 s15, s2, 5
    s_lshl_b32 s15, s15, 12
    s_add_u32 s15, s15, 16842752
    v_lshl_add_u32 v26, v1, 7, s15
    s_waitcnt vmcnt(0)
    v_mov_b32 v28, 81612
    v_mov_b32 v29, 1
    s_mov_b64 exec, 1
    ds_add_rtn_u32 v30, v28, v29
    s_waitcnt lgkmcnt(0)
    v_readfirstlane_b32 s58, v30
    s_mov_b64 exec, -1
    s_cmp_eq_u32 s58, 3
    s_cbranch_scc0 k_final
    s_add_u32 s44, s40, s15
    s_addc_u32 s45, s41, 0
    s_mov_b32 s46, 1
    s_atomic_add s46, s[44:45], 12
    s_atomic_add s46, s[44:45], 140
    s_atomic_add s46, s[44:45], 268
    s_atomic_add s46, s[44:45], 396
    s_atomic_add s46, s[44:45], 524
    s_atomic_add s46, s[44:45], 652
    s_atomic_add s46, s[44:45], 780
    s_atomic_add s46, s[44:45], 908
    s_atomic_add s46, s[44:45], 1036
    s_atomic_add s46, s[44:45], 1164
    s_atomic_add s46, s[44:45], 1292
    s_atomic_add s46, s[44:45], 1420
    s_atomic_add s46, s[44:45], 1548
    s_atomic_add s46, s[44:45], 1676
    s_atomic_add s46, s[44:45], 1804
    s_atomic_add s46, s[44:45], 1932
    s_atomic_add s46, s[44:45], 2060
    s_atomic_add s46, s[44:45], 2188
    s_atomic_add s46, s[44:45], 2316
    s_atomic_add s46, s[44:45], 2444
    s_atomic_add s46, s[44:45], 2572
    s_atomic_add s46, s[44:45], 2700
    s_atomic_add s46, s[44:45], 2828
    s_atomic_add s46, s[44:45], 2956
    s_atomic_add s46, s[44:45], 3084
    s_atomic_add s46, s[44:45], 3212
    s_atomic_add s46, s[44:45], 3340
    s_atomic_add s46, s[44:45], 3468
    s_atomic_add s46, s[44:45], 3596
    s_atomic_add s46, s[44:45], 3724
    s_atomic_add s46, s[44:45], 3852
    s_atomic_add s46, s[44:45], 3980
    v_lshrrev_b32 v14, 3, v1
    v_and_b32 v15, 7, v1
    v_lshlrev_b32 v15, 4, v15
    v_mul_u32_u24 v16, 4224, v14
    v_mul_u32_u24 v17, 144, v14
    s_mul_i32 s15, s12, 270336
    s_and_b32 s13, s2, 7
    s_lshl_b32 s13, s13, 2
    s_add_u32 s13, s13, s8
    s_lshl_b32 s13, s13, 7
    s_add_u32 s15, s15, s13
    s_add_u32 s15, s15, 14680064
    v_add3_u32 v16, v16, v15, s15
    v_add_u32 v17, v17, v15
    v_add_u32 v17, 65536, v17
    s_mov_b32 s27, 0
    s_mov_b32 s59, 0
k_c4_l:
    s_waitcnt lgkmcnt(0)
    s_cmp_eq_u32 s27, 32
    s_cbranch_scc1 k_c4_d
    s_add_u32 s59, s59, 1
    s_sleep 2
    s_cmp_lt_u32 s59, 256
    s_cbranch_scc0 k_c4_v
    s_load_dword s27, s[28:29], 12 glc
    s_branch k_c4_l
k_c4_v:
    v_mov_b32 v13, 0
    global_load_dword v13, v13, s[28:29] offset:12 sc1
    s_waitcnt vmcnt(0)
    v_readfirstlane_b32 s27, v13
    s_cmp_lt_u32 s59, 40000
    s_cbranch_scc1 k_c4_l
k_c4_d:
    global_load_dwordx4 v[32:35], v16, s[40:41] sc1
    v_add_u32 v16, 33792, v16
    global_load_dwordx4 v[36:39], v16, s[40:41] sc1
    v_add_u32 v16, 33792, v16
    global_load_dwordx4 v[40:43], v16, s[40:41] sc1
    v_add_u32 v16, 33792, v16
    global_load_dwordx4 v[44:47], v16, s[40:41] sc1
    v_add_u32 v16, 33792, v16
    global_load_dwordx4 v[48:51], v16, s[40:41] sc1
    v_add_u32 v16, 33792, v16
    global_load_dwordx4 v[52:55], v16, s[40:41] sc1
    v_add_u32 v16, 33792, v16
    global_load_dwordx4 v[56:59], v16, s[40:41] sc1
    v_add_u32 v16, 33792, v16
    global_load_dwordx4 v[60:63], v16, s[40:41] sc1
    s_waitcnt vmcnt(7)
    ds_write_b128 v17, v[32:35] offset:0
    s_waitcnt vmcnt(6)
    ds_write_b128 v17, v[36:39] offset:1152
    s_waitcnt vmcnt(5)
    ds_write_b128 v17, v[40:43] offset:2304
    s_waitcnt vmcnt(4)
    ds_write_b128 v17, v[44:47] offset:3456
    s_waitcnt vmcnt(3)
    ds_write_b128 v17, v[48:51] offset:4608
    s_waitcnt vmcnt(2)
    ds_write_b128 v17, v[52:55] offset:5760
    s_waitcnt vmcnt(1)
    ds_write_b128 v17, v[56:59] offset:6912
    s_waitcnt vmcnt(0)
    ds_write_b128 v17, v[60:63] offset:8064
    s_branch k_final
k_spare:
    s_sub_u32 s6, s2, 224
    s_lshl_b32 s13, s6, 3
    s_add_u32 s13, s13, s3
    s_mov_b32 s59, s13
    s_mul_i32 s60, s13, 7168
    s_mul_i32 s61, s3, 7296
    v_min_u32 v5, 48, v1
    s_lshr_b32 s14, s13, 1
    s_mul_i32 s14, s14, 49
    v_add_lshl_u32 v6, v5, s14, 8
    s_mul_i32 s14, s13, 49
    v_add_lshl_u32 v5, v5, s14, 7
    v_mov_b64 v[24:25], 0
    v_mov_b64 v[26:27], 0
    s_mul_i32 s14, s6, 896
    s_add_u32 s14, s14, 16842752
    v_min_u32 v13, 880, v10
    v_add_u32 v13, s14, v13
    v_mov_b32 v7, 1
    s_lshl_b32 s13, s8, 3
    s_add_u32 s13, s13, s3
    s_lshr_b32 s14, s13, 1
    s_mul_i32 s14, s14, 28
    v_add_u32 v2, s14, v20
    v_min_u32 v3, 6, v22
    v_lshlrev_b32 v3, 8, v3
    s_mul_i32 s14, s9, 1792
    s_add_u32 s14, s14, 128
    v_add_u32 v3, s14, v3
    s_and_b32 s13, s13, 1
    s_cmp_eq_u32 s13, 0
    s_waitcnt lgkmcnt(0)
    s_cselect_b32 s44, s32, s34
    s_cselect_b32 s45, s33, s35
    s_cmp_eq_u32 s3, 0
    s_cbranch_scc0 k_r0
    global_store_dwordx4 v13, v[24:27], s[40:41] sc1
    s_waitcnt vmcnt(0)
    s_mov_b64 exec, 1
    global_atomic_add v24, v7, s[98:99] sc1
    s_mov_b64 exec, -1
k_r0:
    s_mov_b32 s48, s16
    s_mov_b32 s49, s17
    s_mov_b32 s50, 1835008
    s_mov_b32 exec_hi, 0x00ffffff
    s_add_u32 m0, s61, 0
    s_add_u32 s58, s60, 0
    buffer_load_dwordx4 v10, s[48:51], s58 offen lds
    s_add_u32 m0, s61, 912
    s_add_u32 s58, s60, 896
    buffer_load_dwordx4 v10, s[48:51], s58 offen lds
    s_add_u32 m0, s61, 1824
    s_add_u32 s58, s60, 1792
    buffer_load_dwordx4 v10, s[48:51], s58 offen lds
    s_add_u32 m0, s61, 2736
    s_add_u32 s58, s60, 2688
    buffer_load_dwordx4 v10, s[48:51], s58 offen lds
    s_add_u32 m0, s61, 3648
    s_add_u32 s58, s60, 3584
    buffer_load_dwordx4 v10, s[48:51], s58 offen lds
    s_add_u32 m0, s61, 4560
    s_add_u32 s58, s60, 4480
    buffer_load_dwordx4 v10, s[48:51], s58 offen lds
    s_add_u32 m0, s61, 5472
    s_add_u32 s58, s60, 5376
    buffer_load_dwordx4 v10, s[48:51], s58 offen lds
    s_add_u32 m0, s61, 6384
    s_add_u32 s58, s60, 6272
    buffer_load_dwordx4 v10, s[48:51], s58 offen lds
    s_mov_b32 exec_hi, -1
    v_lshlrev_b32 v30, 4, v22
    global_load_dwordx4 v[64:67], v30, s[38:39] offset:0
    global_load_dwordx4 v[68:71], v30, s[38:39] offset:128
    global_load_dwordx4 v[72:75], v30, s[38:39] offset:256
    global_load_dwordx4 v[76:79], v30, s[38:39] offset:384
    global_load_dwordx4 v[80:83], v30, s[38:39] offset:512
    global_load_dwordx4 v[84:87], v30, s[38:39] offset:640
    global_load_dwordx4 v[88:91], v30, s[38:39] offset:768
    v_mul_u32_u24 v31, 912, v20
    v_add3_u32 v31, v31, v30, s61
    v_and_b32 v48, 3, v1
    v_lshrrev_b32 v49, 5, v1
    v_lshl_add_u32 v48, v49, 2, v48
    v_bfe_u32 v49, v1, 2, 2
    v_lshl_add_u32 v48, v48, 3, v49
    v_mul_u32_u24 v48, 912, v48
    v_bfe_u32 v49, v1, 4, 1
    v_lshl_add_u32 v48, v49, 3, v48
    s_mul_i32 s13, s3, 112
    v_add_u32 v48, s13, v48
    v_and_b32 v49, 4, v1
    v_lshlrev_b32 v49, 3, v49
    v_and_b32 v50, 32, v1
    v_lshrrev_b32 v50, 1, v50
    v_and_b32 v51, 3, v1
    v_lshlrev_b32 v51, 2, v51
    v_add3_u32 v49, v49, v50, v51
    v_bfe_u32 v50, v1, 3, 2
    v_add_lshl_u32 v49, v49, v50, 2
    s_mul_i32 s13, s3, 56
    v_add_u32 v50, s13, v20
    v_mul_u32_u24 v50, 4224, v50
    s_lshl_b32 s13, s6, 7
    s_add_u32 s13, s13, 10485760
    v_add3_u32 v50, v50, v30, s13
    s_waitcnt vmcnt(0)
    ds_read_b128 v[96:99], v31 offset:0
    ds_read_b128 v[100:103], v31 offset:128
    ds_read_b128 v[104:107], v31 offset:256
    ds_read_b128 v[108:111], v31 offset:384
    ds_read_b128 v[112:115], v31 offset:512
    ds_read_b128 v[116:119], v31 offset:640
    ds_read_b128 v[120:123], v31 offset:768
    s_barrier
    v_mov_b32 v8, v5
    ds_read_b64_tr_b16 v[128:129], v48 offset:0
    ds_read_b64_tr_b16 v[130:131], v48 offset:3648
    ds_read_b64_tr_b16 v[132:133], v48 offset:16
    ds_read_b64_tr_b16 v[134:135], v48 offset:3664
    ds_read_b64_tr_b16 v[136:137], v48 offset:32
    ds_read_b64_tr_b16 v[138:139], v48 offset:3680
    ds_read_b64_tr_b16 v[140:141], v48 offset:48
    ds_read_b64_tr_b16 v[142:143], v48 offset:3696
    ds_read_b64_tr_b16 v[144:145], v48 offset:64
    ds_read_b64_tr_b16 v[146:147], v48 offset:3712
    ds_read_b64_tr_b16 v[148:149], v48 offset:80
    ds_read_b64_tr_b16 v[150:151], v48 offset:3728
    ds_read_b64_tr_b16 v[152:153], v48 offset:96
    ds_read_b64_tr_b16 v[154:155], v48 offset:3744
    v_mov_b64 v[60:61], 0
    s_waitcnt lgkmcnt(14)
    v_dot2c_f32_bf16 v60, v96, v64
    v_dot2c_f32_bf16 v61, v97, v65
    v_dot2c_f32_bf16 v60, v98, v66
    v_dot2c_f32_bf16 v61, v99, v67
    v_dot2c_f32_bf16 v60, v100, v68
    v_dot2c_f32_bf16 v61, v101, v69
    v_dot2c_f32_bf16 v60, v102, v70
    v_dot2c_f32_bf16 v61, v103, v71
    v_dot2c_f32_bf16 v60, v104, v72
    v_dot2c_f32_bf16 v61, v105, v73
    v_dot2c_f32_bf16 v60, v106, v74
    v_dot2c_f32_bf16 v61, v107, v75
    v_dot2c_f32_bf16 v60, v108, v76
    v_dot2c_f32_bf16 v61, v109, v77
    v_dot2c_f32_bf16 v60, v110, v78
    v_dot2c_f32_bf16 v61, v111, v79
    v_dot2c_f32_bf16 v60, v112, v80
    v_dot2c_f32_bf16 v61, v113, v81
    v_dot2c_f32_bf16 v60, v114, v82
    v_dot2c_f32_bf16 v61, v115, v83
    v_dot2c_f32_bf16 v60, v116, v84
    v_dot2c_f32_bf16 v61, v117, v85
    v_dot2c_f32_bf16 v60, v118, v86
    v_dot2c_f32_bf16 v61, v119, v87
    v_dot2c_f32_bf16 v60, v120, v88
    v_dot2c_f32_bf16 v61, v121, v89
    v_dot2c_f32_bf16 v60, v122, v90
    v_dot2c_f32_bf16 v61, v123, v91
    s_waitcnt lgkmcnt(0)
    ds_bpermute_b32 v160, v49, v128
    ds_bpermute_b32 v161, v49, v129
    ds_bpermute_b32 v162, v49, v130
    ds_bpermute_b32 v163, v49, v131
    ds_bpermute_b32 v164, v49, v132
    ds_bpermute_b32 v165, v49, v133
    ds_bpermute_b32 v166, v49, v134
    ds_bpermute_b32 v167, v49, v135
    ds_bpermute_b32 v168, v49, v136
    ds_bpermute_b32 v169, v49, v137
    ds_bpermute_b32 v170, v49, v138
    ds_bpermute_b32 v171, v49, v139
    s_waitcnt lgkmcnt(8)
    global_store_dwordx4 v50, v[160:163], s[40:41] sc1
    v_add_u32 v50, 33792, v50
    ds_bpermute_b32 v172, v49, v140
    ds_bpermute_b32 v173, v49, v141
    ds_bpermute_b32 v174, v49, v142
    ds_bpermute_b32 v175, v49, v143
    s_waitcnt lgkmcnt(8)
    global_store_dwordx4 v50, v[164:167], s[40:41] sc1
    v_add_u32 v50, 33792, v50
    ds_bpermute_b32 v176, v49, v144
    ds_bpermute_b32 v177, v49, v145
    ds_bpermute_b32 v178, v49, v146
    ds_bpermute_b32 v179, v49, v147
    s_waitcnt lgkmcnt(8)
    global_store_dwordx4 v50, v[168:171], s[40:41] sc1
    v_add_u32 v50, 33792, v50
    ds_bpermute_b32 v180, v49, v148
    ds_bpermute_b32 v181, v49, v149
    ds_bpermute_b32 v182, v49, v150
    ds_bpermute_b32 v183, v49, v151
    s_waitcnt lgkmcnt(8)
    global_store_dwordx4 v50, v[172:175], s[40:41] sc1
    v_add_u32 v50, 33792, v50
    ds_bpermute_b32 v184, v49, v152
    ds_bpermute_b32 v185, v49, v153
    ds_bpermute_b32 v186, v49, v154
    ds_bpermute_b32 v187, v49, v155
    s_waitcnt lgkmcnt(8)
    global_store_dwordx4 v50, v[176:179], s[40:41] sc1
    v_add_u32 v50, 33792, v50
    s_waitcnt lgkmcnt(4)
    global_store_dwordx4 v50, v[180:183], s[40:41] sc1
    v_add_u32 v50, 33792, v50
    s_waitcnt lgkmcnt(0)
    global_store_dwordx4 v50, v[184:187], s[40:41] sc1
    v_add_u32 v50, 33792, v50
    v_add_f32 v60, v60, v61
    s_nop 1
    v_add_f32_dpp v60, v60, v60 quad_perm:[1,0,3,2] row_mask:0xf bank_mask:0xf
    s_nop 1
    v_add_f32_dpp v60, v60, v60 quad_perm:[2,3,0,1] row_mask:0xf bank_mask:0xf
    s_nop 1
    v_add_f32_dpp v60, v60, v60 row_half_mirror row_mask:0xf bank_mask:0xf
    v_cvt_pk_bf16_f32 v60, v60, v60
    v_and_b32 v60, 0xffff0000, v60
    v_mul_f32 v60, 0xbfb8aa3b, v60
    v_exp_f32 v60, v60
    s_nop 0
    v_add_f32 v60, 1.0, v60
    v_rcp_f32 v60, v60
    s_nop 0
    v_cvt_pk_bf16_f32 v60, v60, v60
    v_and_b32 v60, 0xffff0000, v60
    v_sub_f32 v61, 1.0, v60
    v_cvt_pk_bf16_f32 v60, v60, v61
    s_lshl_b32 s13, s59, 5
    s_add_u32 s13, s13, 16777216
    v_lshl_add_u32 v54, v20, 2, s13
    global_store_dword v54, v60, s[40:41] sc1
    v_min_u32 v5, 55, v1
    s_mul_i32 s13, s7, 56
    v_add_lshl_u32 v5, v5, s13, 7
    v_add_u32 v5, 16842752, v5
    global_load_dword v6, v24, s[98:99] sc1
    s_waitcnt vmcnt(0)
    s_barrier
    s_cmp_lt_u32 s3, 4
    s_cbranch_scc0 k_r2
    s_mov_b32 s59, 40000
k_r1:
    v_readfirstlane_b32 s58, v6
    s_nop 0
    s_cmp_ge_u32 s58, 32
    s_cbranch_scc1 k_r1d
    s_sub_u32 s59, s59, 1
    s_cmp_eq_u32 s59, 0
    s_cbranch_scc1 k_r1d
    global_load_dword v6, v24, s[98:99] sc1
    s_waitcnt vmcnt(0)
    s_branch k_r1
k_r1d:
    s_mov_b32 exec_hi, 0x00ffffff
    global_atomic_add v5, v7, s[40:41] sc1
    s_mov_b32 exec_hi, -1
k_r2:
    global_load_dword v0, v8, s[36:37]
    s_endpgm
k_y:
    s_waitcnt vmcnt(0) lgkmcnt(0)
    s_barrier
    s_add_u32 s57, s57, 229376
    s_cmp_eq_u32 s57, 1605632
    s_cselect_b32 s57, 0, s57
    s_add_u32 m0, s14, 49152
    s_mov_b32 s58, s56
    buffer_load_dwordx4 v232, s[44:47], s58 offen offset:0  lds
    buffer_load_dwordx4 v233, s[44:47], s58 offen offset:1024  lds
    buffer_load_dwordx4 v234, s[44:47], s58 offen offset:2048  lds
    buffer_load_dwordx4 v235, s[44:47], s58 offen offset:3072  lds
    s_add_u32 s56, s56, 128
    s_cmp_eq_u32 s56, 896
    s_cselect_b32 s56, 0, s56
    s_add_u32 m0, s15, 147456
    s_mov_b32 s58, s57
    buffer_load_dwordx4 v240, s[48:51], s58 offen offset:0  lds
    buffer_load_dwordx4 v241, s[48:51], s58 offen offset:1024  lds
    s_add_u32 m0, s15, 155648
    s_add_u32 s57, s57, 229376
    buffer_load_dwordx4 v242, s[52:55], s58 offen offset:0  lds
    buffer_load_dwordx4 v243, s[52:55], s58 offen offset:1024  lds
    s_cmp_eq_u32 s57, 1605632
    s_cselect_b32 s57, 0, s57
    s_add_u32 m0, s14, 65536
    s_mov_b32 s58, s56
    buffer_load_dwordx4 v232, s[44:47], s58 offen offset:0  lds
    buffer_load_dwordx4 v233, s[44:47], s58 offen offset:1024  lds
    buffer_load_dwordx4 v234, s[44:47], s58 offen offset:2048  lds
    buffer_load_dwordx4 v235, s[44:47], s58 offen offset:3072  lds
    s_add_u32 s56, s56, 128
    s_cmp_eq_u32 s56, 896
    s_cselect_b32 s56, 0, s56
    s_and_b32 s13, s7, 2
    s_mul_i32 s13, s13, 4608
    v_add_u32 v16, s13, v10
    v_lshl_add_u32 v17, v1, 3, s13
    v_lshl_add_u32 v18, v1, 2, s13
    ds_read_b128 v[80:83], v16 offset:23104
    ds_read_b64 v[84:85], v17 offset:24128
    ds_read_b64 v[86:87], v17 offset:24640
    ds_read_b32 v88, v16 offset:23100
    ds_read_b32 v89, v17 offset:24136
    ds_read_b32 v90, v17 offset:24124
    ds_read_b32 v91, v17 offset:24648
    ds_read_b32 v92, v18 offset:25152
    ds_read_b32 v93, v18 offset:25156
    ds_read_b32 v94, v18 offset:25408
    ds_read_b32 v95, v18 offset:25412
    ds_read_b128 v[32:35], v16 offset:64
    ds_read_b64 v[36:37], v17 offset:1088
    ds_read_b64 v[38:39], v17 offset:1600
    ds_read_b32 v40, v16 offset:60
    ds_read_b32 v41, v17 offset:1096
    ds_read_b32 v42, v17 offset:1084
    ds_read_b32 v43, v17 offset:1608
    ds_read_b32 v44, v18 offset:2112
    ds_read_b32 v45, v18 offset:2116
    ds_read_b32 v46, v18 offset:2368
    ds_read_b32 v47, v18 offset:2372
    s_waitcnt vmcnt(8)
    s_barrier
    s_add_u32 m0, s15, 114688
    s_mov_b32 s58, s57
    buffer_load_dwordx4 v240, s[48:51], s58 offen offset:0  lds
    buffer_load_dwordx4 v241, s[48:51], s58 offen offset:1024  lds
    s_add_u32 m0, s15, 122880
    s_add_u32 s57, s57, 229376
    buffer_load_dwordx4 v242, s[52:55], s58 offen offset:0  lds
    buffer_load_dwordx4 v243, s[52:55], s58 offen offset:1024  lds
    s_cmp_eq_u32 s57, 1605632
    s_cselect_b32 s57, 0, s57
    ds_read_b128 v[48:51], v16 offset:4672
    ds_read_b64 v[52:53], v17 offset:5696
    ds_read_b64 v[54:55], v17 offset:6208
    ds_read_b32 v56, v16 offset:4668
    ds_read_b32 v57, v17 offset:5704
    ds_read_b32 v58, v17 offset:5692
    ds_read_b32 v59, v17 offset:6216
    ds_read_b32 v60, v18 offset:6720
    ds_read_b32 v61, v18 offset:6724
    ds_read_b32 v62, v18 offset:6976
    ds_read_b32 v63, v18 offset:6980
    s_add_u32 m0, s14, 81920
    s_mov_b32 s58, s56
    buffer_load_dwordx4 v232, s[44:47], s58 offen offset:0  lds
    buffer_load_dwordx4 v233, s[44:47], s58 offen offset:1024  lds
    buffer_load_dwordx4 v234, s[44:47], s58 offen offset:2048  lds
    buffer_load_dwordx4 v235, s[44:47], s58 offen offset:3072  lds
    s_add_u32 s56, s56, 128
    s_cmp_eq_u32 s56, 896
    s_cselect_b32 s56, 0, s56
    s_waitcnt vmcnt(8) lgkmcnt(0)
    s_barrier
    s_add_u32 m0, s15, 131072
    s_mov_b32 s58, s57
    buffer_load_dwordx4 v240, s[48:51], s58 offen offset:0  lds
    buffer_load_dwordx4 v241, s[48:51], s58 offen offset:1024  lds
    s_add_u32 m0, s15, 139264
    s_add_u32 s57, s57, 229376
    buffer_load_dwordx4 v242, s[52:55], s58 offen offset:0  lds
    buffer_load_dwordx4 v243, s[52:55], s58 offen offset:1024  lds
    s_cmp_eq_u32 s57, 1605632
    s_cselect_b32 s57, 0, s57
    ds_read_b128 v[64:67], v16 offset:18496
    ds_read_b64 v[68:69], v17 offset:19520
    ds_read_b64 v[70:71], v17 offset:20032
    ds_read_b32 v72, v16 offset:18492
    ds_read_b32 v73, v17 offset:19528
    ds_read_b32 v74, v17 offset:19516
    ds_read_b32 v75, v17 offset:20040
    ds_read_b32 v76, v18 offset:20544
    ds_read_b32 v77, v18 offset:20548
    ds_read_b32 v78, v18 offset:20800
    ds_read_b32 v79, v18 offset:20804
    s_add_u32 m0, s14, 32768
    s_mov_b32 s58, s56
    buffer_load_dwordx4 v232, s[44:47], s58 offen offset:0  lds
    buffer_load_dwordx4 v233, s[44:47], s58 offen offset:1024  lds
    buffer_load_dwordx4 v234, s[44:47], s58 offen offset:2048  lds
    buffer_load_dwordx4 v235, s[44:47], s58 offen offset:3072  lds
    s_add_u32 s56, s56, 128
    s_cmp_eq_u32 s56, 896
    s_cselect_b32 s56, 0, s56
    s_waitcnt vmcnt(8) lgkmcnt(0)
    s_barrier
    s_add_u32 m0, s15, 147456
    s_mov_b32 s58, s57
    buffer_load_dwordx4 v240, s[48:51], s58 offen offset:0  lds
    buffer_load_dwordx4 v241, s[48:51], s58 offen offset:1024  lds
    s_add_u32 m0, s15, 155648
    s_add_u32 s57, s57, 229376
    buffer_load_dwordx4 v242, s[52:55], s58 offen offset:0  lds
    buffer_load_dwordx4 v243, s[52:55], s58 offen offset:1024  lds
    s_cmp_eq_u32 s57, 1605632
    s_cselect_b32 s57, 0, s57
    v_add_f32 v32, v32, v48
    v_add_f32 v64, v64, v80
    v_add_f32 v33, v33, v49
    v_add_f32 v65, v65, v81
    v_add_f32 v34, v34, v50
    v_add_f32 v66, v66, v82
    v_add_f32 v35, v35, v51
    v_add_f32 v67, v67, v83
    v_add_f32 v36, v36, v52
    v_add_f32 v68, v68, v84
    v_add_f32 v37, v37, v53
    v_add_f32 v69, v69, v85
    v_add_f32 v38, v38, v54
    v_add_f32 v70, v70, v86
    v_add_f32 v39, v39, v55
    v_add_f32 v71, v71, v87
    v_add_f32 v40, v40, v56
    v_add_f32 v72, v72, v88
    v_add_f32 v41, v41, v57
    v_add_f32 v73, v73, v89
    v_add_f32 v42, v42, v58
    v_add_f32 v74, v74, v90
    v_add_f32 v43, v43, v59
    v_add_f32 v75, v75, v91
    v_add_f32 v44, v44, v60
    v_add_f32 v76, v76, v92
    v_add_f32 v45, v45, v61
    v_add_f32 v77, v77, v93
    v_add_f32 v46, v46, v62
    v_add_f32 v78, v78, v94
    v_add_f32 v47, v47, v63
    v_add_f32 v79, v79, v95
    s_add_u32 m0, s14, 0
    s_mov_b32 s58, s56
    buffer_load_dwordx4 v232, s[44:47], s58 offen offset:0  lds
    buffer_load_dwordx4 v233, s[44:47], s58 offen offset:1024  lds
    buffer_load_dwordx4 v234, s[44:47], s58 offen offset:2048  lds
    buffer_load_dwordx4 v235, s[44:47], s58 offen offset:3072  lds
    s_add_u32 s56, s56, 128
    s_cmp_eq_u32 s56, 896
    s_cselect_b32 s56, 0, s56
    s_waitcnt vmcnt(8)
    s_barrier
    s_add_u32 m0, s15, 114688
    s_mov_b32 s58, s57
    buffer_load_dwordx4 v240, s[48:51], s58 offen offset:0  lds
    buffer_load_dwordx4 v241, s[48:51], s58 offen offset:1024  lds
    s_add_u32 m0, s15, 122880
    s_add_u32 s57, s57, 229376
    buffer_load_dwordx4 v242, s[52:55], s58 offen offset:0  lds
    buffer_load_dwordx4 v243, s[52:55], s58 offen offset:1024  lds
    s_cmp_eq_u32 s57, 1605632
    s_cselect_b32 s57, 0, s57
    v_add_f32 v32, v32, v64
    v_add_f32 v33, v33, v65
    v_add_f32 v34, v34, v66
    v_add_f32 v35, v35, v67
    v_add_f32 v36, v36, v68
    v_add_f32 v37, v37, v69
    v_add_f32 v38, v38, v70
    v_add_f32 v39, v39, v71
    v_add_f32 v40, v40, v72
    v_add_f32 v41, v41, v73
    v_add_f32 v42, v42, v74
    v_add_f32 v43, v43, v75
    v_add_f32 v44, v44, v76
    v_add_f32 v45, v45, v77
    v_add_f32 v46, v46, v78
    v_add_f32 v47, v47, v79
    v_and_b32 v19, 1, v1
    v_cmp_eq_u32 vcc, 0, v19
    s_nop 1
    v_cndmask_b32 v48, v45, v44, vcc
    v_cndmask_b32 v49, v47, v46, vcc
    v_cmp_ne_u32 vcc, 0, v1
    s_nop 1
    v_cndmask_b32 v40, 0, v40, vcc
    v_cndmask_b32 v42, v42, v36, vcc
    s_add_u32 m0, s14, 16384
    s_mov_b32 s58, s56
    buffer_load_dwordx4 v232, s[44:47], s58 offen offset:0  lds
    buffer_load_dwordx4 v233, s[44:47], s58 offen offset:1024  lds
    buffer_load_dwordx4 v234, s[44:47], s58 offen offset:2048  lds
    buffer_load_dwordx4 v235, s[44:47], s58 offen offset:3072  lds
    s_add_u32 s56, s56, 128
    s_cmp_eq_u32 s56, 896
    s_cselect_b32 s56, 0, s56
    s_load_dword s27, s[98:99], 0
    s_waitcnt vmcnt(8)
    s_barrier
    s_add_u32 m0, s15, 131072
    s_add_u32 s58, s57, 128
    buffer_load_dwordx4 v240, s[48:51], s58 offen offset:0  lds
    buffer_load_dwordx4 v241, s[48:51], s58 offen offset:1024  lds
    s_add_u32 m0, s15, 139264
    s_add_u32 s57, s57, 229376
    buffer_load_dwordx4 v242, s[52:55], s58 offen offset:0  lds
    buffer_load_dwordx4 v243, s[52:55], s58 offen offset:1024  lds
    s_cmp_eq_u32 s57, 1605632
    s_cselect_b32 s57, 0, s57
    v_cvt_pk_bf16_f32 v209, v39, v39
    v_cvt_pk_bf16_f32 v211, v38, v38
    v_cvt_pk_bf16_f32 v212, v45, v45
    v_cvt_pk_bf16_f32 v214, v44, v44
    v_cvt_pk_bf16_f32 v215, v44, v44
    v_cvt_pk_bf16_f32 v216, v47, v47
    v_cvt_pk_bf16_f32 v218, v46, v46
    v_cvt_pk_bf16_f32 v219, v46, v46
    s_cmp_eq_u32 s61, 0
    s_cbranch_scc0 k_eo
    v_cvt_pk_bf16_f32 v204, v35, v34
    v_cvt_pk_bf16_f32 v205, v33, v32
    v_cvt_pk_bf16_f32 v206, v41, v37
    v_cvt_pk_bf16_f32 v207, v36, v36
    v_cvt_pk_bf16_f32 v208, v43, v43
    v_cvt_pk_bf16_f32 v210, v39, v38
    v_cvt_pk_bf16_f32 v213, v45, v48
    v_cvt_pk_bf16_f32 v217, v47, v49
    s_branch k_ew
k_eo:
    v_cvt_pk_bf16_f32 v204, v34, v33
    v_cvt_pk_bf16_f32 v205, v32, v40
    v_cvt_pk_bf16_f32 v206, v37, v36
    v_cvt_pk_bf16_f32 v207, v36, v42
    v_cvt_pk_bf16_f32 v208, v43, v39
    v_cvt_pk_bf16_f32 v210, v38, v38
    v_cvt_pk_bf16_f32 v213, v48, v44
    v_cvt_pk_bf16_f32 v217, v49, v46
k_ew:
    v_add_u32 v6, 98304, v2
    v_add_u32 v4, 131072, v3
    v_xor_b32 v7, 32, v6
    v_xor_b32 v5, 32, v4
    v_xor_b32 v8, 64, v6
    v_xor_b32 v9, 96, v6
    v_lshrrev_b32 v20, 3, v1
    v_and_b32 v22, 7, v1
    v_mul_u32_u24 v160, 896, v20
    v_and_b32 v161, 6, v20
    v_xor_b32 v161, v161, v22
    v_lshl_add_u32 v160, v161, 4, v160
    v_add_u32 v161, 6144, v160
    v_add_u32 v162, 12288, v160
    v_add_u32 v163, 18432, v160
    v_bfe_u32 v164, v1, 2, 3
    v_lshlrev_b32 v164, 7, v164
    v_lshrrev_b32 v165, 5, v1
    v_lshl_add_u32 v164, v165, 11, v164
    v_bfe_u32 v165, v1, 3, 2
    v_lshl_add_u32 v164, v165, 5, v164
    v_and_b32 v165, 3, v1
    v_lshl_add_u32 v164, v165, 3, v164
    v_add_u32 v164, s14, v164
    v_xor_b32 v165, 32, v164
    v_xor_b32 v166, 64, v164
    v_xor_b32 v167, 96, v164
    s_waitcnt vmcnt(4) lgkmcnt(0)
    s_barrier
    s_add_u32 m0, s15, 147456
    s_add_u32 s58, s57, 128
    buffer_load_dwordx4 v240, s[48:51], s58 offen offset:0  lds
    buffer_load_dwordx4 v241, s[48:51], s58 offen offset:1024  lds
    s_add_u32 m0, s15, 155648
    s_add_u32 s57, s57, 229376
    buffer_load_dwordx4 v242, s[52:55], s58 offen offset:0  lds
    buffer_load_dwordx4 v243, s[52:55], s58 offen offset:1024  lds
    s_cmp_eq_u32 s57, 1605632
    s_cselect_b32 s57, 0, s57
    s_mul_i32 s13, s61, 4160
    s_add_u32 s13, s13, s24
    v_lshlrev_b32 v220, 3, v1
    v_sub_u32 v220, s13, v220
    v_sub_u32 v221, s13, v10
    v_min_u32 v48, 39, v1
    v_lshlrev_b32 v48, 4, v48
    v_add_u32 v222, 8256, v48
    v_add_u32 v50, 3520, v48
    v_cmp_gt_u32 vcc, 36, v1
    s_nop 1
    v_cndmask_b32 v222, v50, v222, vcc
    v_add_u32 v222, s24, v222
    v_mov_b32 v224, 0
    v_mov_b32 v225, 0
    v_mov_b32 v226, 0
    v_mov_b32 v227, 0
    v_mov_b32 v52, 0
    s_mov_b32 s59, 40000
k_c0_l:
    s_cmp_ge_u32 s27, 32
    s_cbranch_scc1 k_c0_d
    s_sub_u32 s59, s59, 1
    s_cmp_eq_u32 s59, 0
    s_cbranch_scc1 k_c0_d
    s_sleep 4
    global_load_dword v53, v52, s[98:99] sc1
    s_waitcnt vmcnt(0)
    v_readfirstlane_b32 s27, v53
    s_branch k_c0_l
k_c0_d:
    s_lshl_b32 s13, s10, 1
    s_and_b32 s58, s13, 3
    s_lshl_b32 s58, s58, 3
    s_lshr_b32 s13, s13, 2
    s_add_u32 s13, s13, s58
    s_lshl_b32 s13, s13, 7
    s_add_u32 s13, s13, 16842752
    v_lshrrev_b32 v12, 1, v1
    v_lshlrev_b32 v12, 12, v12
    v_and_b32 v13, 1, v1
    v_lshl_add_u32 v12, v13, 10, v12
    v_add_u32 v12, s13, v12
    s_mov_b32 s19, 0x20000
    s_mov_b32 s23, 0x20000
    v_mov_b32 v168, 81600
    v_mov_b32 v169, 1
    s_waitcnt vmcnt(4)
    s_barrier
    s_mov_b32 s30, 0x102543
    s_mov_b32 s31, 0x396879
    s_mov_b32 s43, 3
    s_mov_b32 s59, 3
    s_call_b64 s[100:101], k_pass
    s_waitcnt lgkmcnt(0)
    v_mfma_f32_32x32x16_bf16 v[80:95], v[16:19], v[24:27], v[80:95]
    ds_read_b64_tr_b16 v[48:49], v4 offset:4096
    ds_read_b64_tr_b16 v[50:51], v4 offset:4608
    ds_read_b128 v[56:59], v8 offset:0
    v_mfma_f32_32x32x16_bf16 v[96:111], v[16:19], v[28:31], v[96:111]
    ds_read_b128 v[60:63], v8 offset:4096
    ds_read_b64_tr_b16 v[52:53], v5 offset:4096
    ds_read_b64_tr_b16 v[54:55], v5 offset:4608
    v_mfma_f32_32x32x16_bf16 v[112:127], v[20:23], v[24:27], v[112:127]
    ds_read_b64_tr_b16 v[64:65], v4 offset:6144
    ds_read_b64_tr_b16 v[66:67], v4 offset:6656
    ds_read_b128 v[72:75], v9 offset:0
    v_mfma_f32_32x32x16_bf16 v[128:143], v[20:23], v[28:31], v[128:143]
    ds_read_b128 v[76:79], v9 offset:4096
    ds_read_b64_tr_b16 v[68:69], v5 offset:6144
    ds_read_b64_tr_b16 v[70:71], v5 offset:6656
    v_mfma_f32_32x32x16_bf16 v[80:95], v[32:35], v[40:43], v[80:95]
    v_add_u32 v6, 32768, v2
    v_add_u32 v4, 98304, v3
    v_xor_b32 v7, 32, v6
    v_mfma_f32_32x32x16_bf16 v[96:111], v[32:35], v[44:47], v[96:111]
    v_xor_b32 v5, 32, v4
    v_xor_b32 v8, 64, v6
    v_xor_b32 v9, 96, v6
    v_mfma_f32_32x32x16_bf16 v[112:127], v[36:39], v[40:43], v[112:127]
    v_mfma_f32_32x32x16_bf16 v[128:143], v[36:39], v[44:47], v[128:143]
    s_waitcnt lgkmcnt(0)
    v_mfma_f32_32x32x16_bf16 v[80:95], v[48:51], v[56:59], v[80:95]
    s_barrier
    s_setprio 1
    v_mfma_f32_32x32x16_bf16 v[96:111], v[48:51], v[60:63], v[96:111]
    ds_read_b64_tr_b16 v[16:17], v4 offset:0
    ds_read_b64_tr_b16 v[18:19], v4 offset:512
    ds_read_b128 v[24:27], v6 offset:0
    v_mfma_f32_32x32x16_bf16 v[112:127], v[52:55], v[56:59], v[112:127]
    ds_read_b128 v[28:31], v6 offset:4096
    ds_read_b64_tr_b16 v[20:21], v5 offset:0
    ds_read_b64_tr_b16 v[22:23], v5 offset:512
    v_mfma_f32_32x32x16_bf16 v[128:143], v[52:55], v[60:63], v[128:143]
    ds_read_b64_tr_b16 v[32:33], v4 offset:2048
    ds_read_b64_tr_b16 v[34:35], v4 offset:2560
    ds_read_b128 v[40:43], v7 offset:0
    v_mfma_f32_32x32x16_bf16 v[80:95], v[64:67], v[72:75], v[80:95]
    ds_read_b128 v[44:47], v7 offset:4096
    ds_read_b64_tr_b16 v[36:37], v5 offset:2048
    ds_read_b64_tr_b16 v[38:39], v5 offset:2560
    v_mfma_f32_32x32x16_bf16 v[96:111], v[64:67], v[76:79], v[96:111]
    ds_write_b64 v220, v[204:205] offset:4088
    ds_write_b64 v220, v[206:207] offset:3576
    ds_write_b128 v221, v[208:211] offset:3056
    v_mfma_f32_32x32x16_bf16 v[112:127], v[68:71], v[72:75], v[112:127]
    ds_write_b128 v221, v[212:215] offset:2032
    ds_write_b128 v221, v[216:219] offset:1008
    ds_write_b128 v222, v[224:227]
    v_mfma_f32_32x32x16_bf16 v[128:143], v[68:71], v[76:79], v[128:143]
    s_mov_b64 exec, 1
    ds_add_u32 v168, v169
    s_mov_b64 exec, -1
    s_waitcnt lgkmcnt(7)
    v_mfma_f32_32x32x16_bf16 v[80:95], v[16:19], v[24:27], v[80:95]
    ds_read_b64_tr_b16 v[48:49], v4 offset:4096
    ds_read_b64_tr_b16 v[50:51], v4 offset:4608
    ds_read_b128 v[56:59], v8 offset:0
    v_mfma_f32_32x32x16_bf16 v[96:111], v[16:19], v[28:31], v[96:111]
    ds_read_b128 v[60:63], v8 offset:4096
    ds_read_b64_tr_b16 v[52:53], v5 offset:4096
    ds_read_b64_tr_b16 v[54:55], v5 offset:4608
    v_mfma_f32_32x32x16_bf16 v[112:127], v[20:23], v[24:27], v[112:127]
    ds_read_b64_tr_b16 v[64:65], v4 offset:6144
    ds_read_b64_tr_b16 v[66:67], v4 offset:6656
    ds_read_b128 v[72:75], v9 offset:0
    v_mfma_f32_32x32x16_bf16 v[128:143], v[20:23], v[28:31], v[128:143]
    ds_read_b128 v[76:79], v9 offset:4096
    ds_read_b64_tr_b16 v[68:69], v5 offset:6144
    ds_read_b64_tr_b16 v[70:71], v5 offset:6656
    v_mfma_f32_32x32x16_bf16 v[80:95], v[32:35], v[40:43], v[80:95]
    v_add_u32 v6, 0, v2
    v_add_u32 v4, 147456, v3
    v_xor_b32 v7, 32, v6
    v_mfma_f32_32x32x16_bf16 v[96:111], v[32:35], v[44:47], v[96:111]
    v_xor_b32 v5, 32, v4
    v_xor_b32 v8, 64, v6
    v_xor_b32 v9, 96, v6
    v_mfma_f32_32x32x16_bf16 v[112:127], v[36:39], v[40:43], v[112:127]
    v_mfma_f32_32x32x16_bf16 v[128:143], v[36:39], v[44:47], v[128:143]
    s_waitcnt lgkmcnt(0)
    v_mfma_f32_32x32x16_bf16 v[80:95], v[48:51], v[56:59], v[80:95]
    ds_read_b64_tr_b16 v[16:17], v4 offset:0
    ds_read_b64_tr_b16 v[18:19], v4 offset:512
    ds_read_b128 v[24:27], v6 offset:0
    v_mfma_f32_32x32x16_bf16 v[96:111], v[48:51], v[60:63], v[96:111]
    ds_read_b128 v[28:31], v6 offset:4096
    ds_read_b64_tr_b16 v[20:21], v5 offset:0
    ds_read_b64_tr_b16 v[22:23], v5 offset:512
    v_mfma_f32_32x32x16_bf16 v[112:127], v[52:55], v[56:59], v[112:127]
    ds_read_b64_tr_b16 v[32:33], v4 offset:2048
    ds_read_b64_tr_b16 v[34:35], v4 offset:2560
    ds_read_b128 v[40:43], v7 offset:0
    v_mfma_f32_32x32x16_bf16 v[128:143], v[52:55], v[60:63], v[128:143]
    ds_read_b128 v[44:47], v7 offset:4096
    ds_read_b64_tr_b16 v[36:37], v5 offset:2048
    ds_read_b64_tr_b16 v[38:39], v5 offset:2560
    v_mfma_f32_32x32x16_bf16 v[80:95], v[64:67], v[72:75], v[80:95]
    s_add_u32 m0, s14, 81920
    s_nop 0
    buffer_load_dwordx4 v160, s[20:23], s32 offen offset:0 lds
    v_mfma_f32_32x32x16_bf16 v[96:111], v[64:67], v[76:79], v[96:111]
    buffer_load_dwordx4 v161, s[20:23], s32 offen offset:1024 lds
    buffer_load_dwordx4 v162, s[20:23], s32 offen offset:2048 lds
    buffer_load_dwordx4 v163, s[20:23], s32 offen offset:3072 lds
    v_mfma_f32_32x32x16_bf16 v[112:127], v[68:71], v[72:75], v[112:127]
    v_mfma_f32_32x32x16_bf16 v[128:143], v[68:71], v[76:79], v[128:143]
    s_waitcnt lgkmcnt(0)
    v_mfma_f32_32x32x16_bf16 v[80:95], v[16:19], v[24:27], v[80:95]
    ds_read_b64_tr_b16 v[48:49], v4 offset:4096
    ds_read_b64_tr_b16 v[50:51], v4 offset:4608
    ds_read_b128 v[56:59], v8 offset:0
    v_mfma_f32_32x32x16_bf16 v[96:111], v[16:19], v[28:31], v[96:111]
    ds_read_b128 v[60:63], v8 offset:4096
    ds_read_b64_tr_b16 v[52:53], v5 offset:4096
    ds_read_b64_tr_b16 v[54:55], v5 offset:4608
    v_mfma_f32_32x32x16_bf16 v[112:127], v[20:23], v[24:27], v[112:127]
    ds_read_b64_tr_b16 v[64:65], v4 offset:6144
    ds_read_b64_tr_b16 v[66:67], v4 offset:6656
    ds_read_b128 v[72:75], v9 offset:0
    v_mfma_f32_32x32x16_bf16 v[128:143], v[20:23], v[28:31], v[128:143]
    ds_read_b128 v[76:79], v9 offset:4096
    ds_read_b64_tr_b16 v[68:69], v5 offset:6144
    ds_read_b64_tr_b16 v[70:71], v5 offset:6656
    v_mfma_f32_32x32x16_bf16 v[80:95], v[32:35], v[40:43], v[80:95]
    v_add_u32 v6, 16384, v2
    v_add_u32 v4, 49152, v3
    v_xor_b32 v7, 32, v6
    v_mfma_f32_32x32x16_bf16 v[96:111], v[32:35], v[44:47], v[96:111]
    v_xor_b32 v5, 32, v4
    v_xor_b32 v8, 64, v6
    v_xor_b32 v9, 96, v6
    v_mfma_f32_32x32x16_bf16 v[112:127], v[36:39], v[40:43], v[112:127]
    v_mfma_f32_32x32x16_bf16 v[128:143], v[36:39], v[44:47], v[128:143]
    s_waitcnt lgkmcnt(0)
    v_mfma_f32_32x32x16_bf16 v[80:95], v[48:51], v[56:59], v[80:95]
    ds_read_b64_tr_b16 v[16:17], v4 offset:0
    ds_read_b64_tr_b16 v[18:19], v4 offset:512
    ds_read_b128 v[24:27], v6 offset:0
    v_mfma_f32_32x32x16_bf16 v[96:111], v[48:51], v[60:63], v[96:111]
    ds_read_b128 v[28:31], v6 offset:4096
    ds_read_b64_tr_b16 v[20:21], v5 offset:0
    ds_read_b64_tr_b16 v[22:23], v5 offset:512
    v_mfma_f32_32x32x16_bf16 v[112:127], v[52:55], v[56:59], v[112:127]
    ds_read_b64_tr_b16 v[32:33], v4 offset:2048
    ds_read_b64_tr_b16 v[34:35], v4 offset:2560
    ds_read_b128 v[40:43], v7 offset:0
    v_mfma_f32_32x32x16_bf16 v[128:143], v[52:55], v[60:63], v[128:143]
    ds_read_b128 v[44:47], v7 offset:4096
    ds_read_b64_tr_b16 v[36:37], v5 offset:2048
    ds_read_b64_tr_b16 v[38:39], v5 offset:2560
    v_mfma_f32_32x32x16_bf16 v[80:95], v[64:67], v[72:75], v[80:95]
    s_add_u32 m0, s14, 131072
    s_nop 0
    buffer_load_dwordx4 v160, s[20:23], s33 offen offset:0 lds
    v_mfma_f32_32x32x16_bf16 v[96:111], v[64:67], v[76:79], v[96:111]
    buffer_load_dwordx4 v161, s[20:23], s33 offen offset:1024 lds
    buffer_load_dwordx4 v162, s[20:23], s33 offen offset:2048 lds
    buffer_load_dwordx4 v163, s[20:23], s33 offen offset:3072 lds
    v_mfma_f32_32x32x16_bf16 v[112:127], v[68:71], v[72:75], v[112:127]
    v_mfma_f32_32x32x16_bf16 v[128:143], v[68:71], v[76:79], v[128:143]
    s_waitcnt lgkmcnt(0)
    v_mfma_f32_32x32x16_bf16 v[80:95], v[16:19], v[24:27], v[80:95]
    ds_read_b64_tr_b16 v[48:49], v4 offset:4096
    ds_read_b64_tr_b16 v[50:51], v4 offset:4608
    ds_read_b128 v[56:59], v8 offset:0
    v_mfma_f32_32x32x16_bf16 v[96:111], v[16:19], v[28:31], v[96:111]
    ds_read_b128 v[60:63], v8 offset:4096
    ds_read_b64_tr_b16 v[52:53], v5 offset:4096
    ds_read_b64_tr_b16 v[54:55], v5 offset:4608
    v_mfma_f32_32x32x16_bf16 v[112:127], v[20:23], v[24:27], v[112:127]
    ds_read_b64_tr_b16 v[64:65], v4 offset:6144
    ds_read_b64_tr_b16 v[66:67], v4 offset:6656
    ds_read_b128 v[72:75], v9 offset:0
    v_mfma_f32_32x32x16_bf16 v[128:143], v[20:23], v[28:31], v[128:143]
    ds_read_b128 v[76:79], v9 offset:4096
    ds_read_b64_tr_b16 v[68:69], v5 offset:6144
    ds_read_b64_tr_b16 v[70:71], v5 offset:6656
    v_mfma_f32_32x32x16_bf16 v[80:95], v[32:35], v[40:43], v[80:95]
    v_mfma_f32_32x32x16_bf16 v[96:111], v[32:35], v[44:47], v[96:111]
    v_mfma_f32_32x32x16_bf16 v[112:127], v[36:39], v[40:43], v[112:127]
    v_mfma_f32_32x32x16_bf16 v[128:143], v[36:39], v[44:47], v[128:143]
    s_waitcnt lgkmcnt(0)
    v_mfma_f32_32x32x16_bf16 v[80:95], v[48:51], v[56:59], v[80:95]
    s_mov_b64 exec, 1
    ds_add_u32 v168, v169 offset:4
    s_mov_b64 exec, -1
    ds_read_b32 v170, v168 offset:4
    v_mfma_f32_32x32x16_bf16 v[96:111], v[48:51], v[60:63], v[96:111]
    v_mfma_f32_32x32x16_bf16 v[112:127], v[52:55], v[56:59], v[112:127]
    v_mfma_f32_32x32x16_bf16 v[128:143], v[52:55], v[60:63], v[128:143]
    v_mfma_f32_32x32x16_bf16 v[80:95], v[64:67], v[72:75], v[80:95]
    v_mfma_f32_32x32x16_bf16 v[96:111], v[64:67], v[76:79], v[96:111]
    v_mfma_f32_32x32x16_bf16 v[112:127], v[68:71], v[72:75], v[112:127]
    v_mfma_f32_32x32x16_bf16 v[128:143], v[68:71], v[76:79], v[128:143]
    s_nop 8
    v_mul_f32 v144, s62, v80
    v_mul_f32 v145, s62, v81
    v_mul_f32 v146, s62, v82
    v_mul_f32 v147, s62, v83
    v_mul_f32 v148, s62, v84
    v_mul_f32 v149, s62, v85
    v_mul_f32 v150, s62, v86
    v_mul_f32 v151, s62, v87
    s_mov_b32 s59, 40000
k_ys:
    s_waitcnt lgkmcnt(0)
    v_readfirstlane_b32 s58, v170
    s_nop 0
    s_cmp_eq_u32 s58, 4
    s_cbranch_scc1 k_ysd
    ds_read_b32 v170, v168 offset:4
    s_sub_u32 s59, s59, 1
    s_cmp_lg_u32 s59, 0
    s_cbranch_scc1 k_ys
k_ysd:
    s_add_u32 m0, s14, 32768
    s_nop 0
    buffer_load_dwordx4 v160, s[20:23], s34 offen offset:0 lds
    v_exp_f32 v144, v144
    v_mul_f32 v80, v80, v88
    v_exp_f32 v145, v145
    v_mul_f32 v81, v81, v89
    v_exp_f32 v146, v146
    v_mul_f32 v82, v82, v90
    v_exp_f32 v147, v147
    v_mul_f32 v83, v83, v91
    v_exp_f32 v148, v148
    buffer_load_dwordx4 v161, s[20:23], s34 offen offset:1024 lds
    v_mul_f32 v84, v84, v92
    v_exp_f32 v149, v149
    v_mul_f32 v85, v85, v93
    v_exp_f32 v150, v150
    v_mul_f32 v86, v86, v94
    v_exp_f32 v151, v151
    v_mul_f32 v87, v87, v95
    v_add_f32 v144, 1.0, v144
    v_add_f32 v145, 1.0, v145
    buffer_load_dwordx4 v162, s[20:23], s34 offen offset:2048 lds
    v_add_f32 v146, 1.0, v146
    v_add_f32 v147, 1.0, v147
    v_add_f32 v148, 1.0, v148
    v_add_f32 v149, 1.0, v149
    v_add_f32 v150, 1.0, v150
    v_add_f32 v151, 1.0, v151
    v_rcp_f32 v144, v144
    v_rcp_f32 v145, v145
    v_rcp_f32 v146, v146
    buffer_load_dwordx4 v163, s[20:23], s34 offen offset:3072 lds
    v_mul_f32 v80, v80, v144
    v_rcp_f32 v147, v147
    v_mul_f32 v81, v81, v145
    v_rcp_f32 v148, v148
    v_mul_f32 v82, v82, v146
    v_rcp_f32 v149, v149
    v_mul_f32 v83, v83, v147
    v_rcp_f32 v150, v150
    v_mul_f32 v84, v84, v148
    s_add_u32 m0, s14, 0
    s_nop 0
    buffer_load_dwordx4 v160, s[20:23], s35 offen offset:0 lds
    v_rcp_f32 v151, v151
    v_mul_f32 v85, v85, v149
    v_mul_f32 v86, v86, v150
    v_mul_f32 v87, v87, v151
    v_cvt_pk_bf16_f32 v88, v80, v81
    v_cvt_pk_bf16_f32 v89, v82, v83
    v_cvt_pk_bf16_f32 v90, v84, v85
    v_cvt_pk_bf16_f32 v91, v86, v87
    global_store_dwordx4 v14, v[88:91], s[40:41] offset:0 sc1
    buffer_load_dwordx4 v161, s[20:23], s35 offen offset:1024 lds
    v_mul_f32 v152, s62, v96
    v_mul_f32 v153, s62, v97
    v_mul_f32 v154, s62, v98
    v_mul_f32 v155, s62, v99
    v_mul_f32 v156, s62, v100
    v_mul_f32 v157, s62, v101
    v_mul_f32 v158, s62, v102
    v_mul_f32 v159, s62, v103
    v_exp_f32 v152, v152
    buffer_load_dwordx4 v162, s[20:23], s35 offen offset:2048 lds
    v_mul_f32 v96, v96, v104
    v_exp_f32 v153, v153
    v_mul_f32 v97, v97, v105
    v_exp_f32 v154, v154
    v_mul_f32 v98, v98, v106
    v_exp_f32 v155, v155
    v_mul_f32 v99, v99, v107
    v_exp_f32 v156, v156
    v_mul_f32 v100, v100, v108
    buffer_load_dwordx4 v163, s[20:23], s35 offen offset:3072 lds
    v_exp_f32 v157, v157
    v_mul_f32 v101, v101, v109
    v_exp_f32 v158, v158
    v_mul_f32 v102, v102, v110
    v_exp_f32 v159, v159
    v_mul_f32 v103, v103, v111
    v_add_f32 v152, 1.0, v152
    v_add_f32 v153, 1.0, v153
    v_add_f32 v154, 1.0, v154
    s_add_u32 m0, s14, 16384
    s_nop 0
    buffer_load_dwordx4 v160, s[20:23], s36 offen offset:0 lds
    v_add_f32 v155, 1.0, v155
    v_add_f32 v156, 1.0, v156
    v_add_f32 v157, 1.0, v157
    v_add_f32 v158, 1.0, v158
    v_add_f32 v159, 1.0, v159
    v_rcp_f32 v152, v152
    v_rcp_f32 v153, v153
    v_rcp_f32 v154, v154
    v_mul_f32 v96, v96, v152
    buffer_load_dwordx4 v161, s[20:23], s36 offen offset:1024 lds
    v_rcp_f32 v155, v155
    v_mul_f32 v97, v97, v153
    v_rcp_f32 v156, v156
    v_mul_f32 v98, v98, v154
    v_rcp_f32 v157, v157
    v_mul_f32 v99, v99, v155
    v_rcp_f32 v158, v158
    v_mul_f32 v100, v100, v156
    v_rcp_f32 v159, v159
    buffer_load_dwordx4 v162, s[20:23], s36 offen offset:2048 lds
    v_mul_f32 v101, v101, v157
    v_mul_f32 v102, v102, v158
    v_mul_f32 v103, v103, v159
    v_cvt_pk_bf16_f32 v104, v96, v97
    v_cvt_pk_bf16_f32 v105, v98, v99
    v_cvt_pk_bf16_f32 v106, v100, v101
    v_cvt_pk_bf16_f32 v107, v102, v103
    global_store_dwordx4 v14, v[104:107], s[40:41] offset:2048 sc1
    v_mul_f32 v144, s62, v112
    buffer_load_dwordx4 v163, s[20:23], s36 offen offset:3072 lds
    v_mul_f32 v145, s62, v113
    v_mul_f32 v146, s62, v114
    v_mul_f32 v147, s62, v115
    v_mul_f32 v148, s62, v116
    v_mul_f32 v149, s62, v117
    v_mul_f32 v150, s62, v118
    v_mul_f32 v151, s62, v119
    v_exp_f32 v144, v144
    v_mul_f32 v112, v112, v120
    s_add_u32 m0, s14, 98304
    s_nop 0
    buffer_load_dwordx4 v160, s[20:23], s37 offen offset:0 lds
    v_exp_f32 v145, v145
    v_mul_f32 v113, v113, v121
    v_exp_f32 v146, v146
    v_mul_f32 v114, v114, v122
    v_exp_f32 v147, v147
    v_mul_f32 v115, v115, v123
    v_exp_f32 v148, v148
    v_mul_f32 v116, v116, v124
    v_exp_f32 v149, v149
    buffer_load_dwordx4 v161, s[20:23], s37 offen offset:1024 lds
    v_mul_f32 v117, v117, v125
    v_exp_f32 v150, v150
    v_mul_f32 v118, v118, v126
    v_exp_f32 v151, v151
    v_mul_f32 v119, v119, v127
    v_add_f32 v144, 1.0, v144
    v_add_f32 v145, 1.0, v145
    v_add_f32 v146, 1.0, v146
    v_add_f32 v147, 1.0, v147
    buffer_load_dwordx4 v162, s[20:23], s37 offen offset:2048 lds
    v_add_f32 v148, 1.0, v148
    v_add_f32 v149, 1.0, v149
    v_add_f32 v150, 1.0, v150
    v_add_f32 v151, 1.0, v151
    v_rcp_f32 v144, v144
    v_rcp_f32 v145, v145
    v_rcp_f32 v146, v146
    v_mul_f32 v112, v112, v144
    v_rcp_f32 v147, v147
    buffer_load_dwordx4 v163, s[20:23], s37 offen offset:3072 lds
    v_mul_f32 v113, v113, v145
    v_rcp_f32 v148, v148
    v_mul_f32 v114, v114, v146
    v_rcp_f32 v149, v149
    v_mul_f32 v115, v115, v147
    v_rcp_f32 v150, v150
    v_mul_f32 v116, v116, v148
    v_rcp_f32 v151, v151
    v_mul_f32 v117, v117, v149
    s_load_dword s27, s[28:29], 4 glc
    s_add_u32 m0, s14, 49152
    s_nop 0
    buffer_load_dwordx4 v160, s[20:23], s38 offen offset:0 lds
    v_mul_f32 v118, v118, v150
    v_mul_f32 v119, v119, v151
    v_cvt_pk_bf16_f32 v120, v112, v113
    v_cvt_pk_bf16_f32 v121, v114, v115
    v_cvt_pk_bf16_f32 v122, v116, v117
    v_cvt_pk_bf16_f32 v123, v118, v119
    global_store_dwordx4 v14, v[120:123], s[40:41] offset:512 sc1
    v_mul_f32 v152, s62, v128
    v_mul_f32 v153, s62, v129
    buffer_load_dwordx4 v161, s[20:23], s38 offen offset:1024 lds
    v_mul_f32 v154, s62, v130
    v_mul_f32 v155, s62, v131
    v_mul_f32 v156, s62, v132
    v_mul_f32 v157, s62, v133
    v_mul_f32 v158, s62, v134
    v_mul_f32 v159, s62, v135
    v_exp_f32 v152, v152
    v_mul_f32 v128, v128, v136
    v_exp_f32 v153, v153
    buffer_load_dwordx4 v162, s[20:23], s38 offen offset:2048 lds
    v_mul_f32 v129, v129, v137
    v_exp_f32 v154, v154
    v_mul_f32 v130, v130, v138
    v_exp_f32 v155, v155
    v_mul_f32 v131, v131, v139
    v_exp_f32 v156, v156
    v_mul_f32 v132, v132, v140
    v_exp_f32 v157, v157
    v_mul_f32 v133, v133, v141
    buffer_load_dwordx4 v163, s[20:23], s38 offen offset:3072 lds
    v_exp_f32 v158, v158
    v_mul_f32 v134, v134, v142
    v_exp_f32 v159, v159
    v_mul_f32 v135, v135, v143
    v_add_f32 v152, 1.0, v152
    v_add_f32 v153, 1.0, v153
    v_add_f32 v154, 1.0, v154
    v_add_f32 v155, 1.0, v155
    v_add_f32 v156, 1.0, v156
    v_add_f32 v157, 1.0, v157
    v_add_f32 v158, 1.0, v158
    v_add_f32 v159, 1.0, v159
    v_rcp_f32 v152, v152
    v_rcp_f32 v153, v153
    v_rcp_f32 v154, v154
    v_mul_f32 v128, v128, v152
    v_rcp_f32 v155, v155
    v_mul_f32 v129, v129, v153
    v_rcp_f32 v156, v156
    v_mul_f32 v130, v130, v154
    v_rcp_f32 v157, v157
    v_mul_f32 v131, v131, v155
    v_rcp_f32 v158, v158
    v_mul_f32 v132, v132, v156
    v_rcp_f32 v159, v159
    v_mul_f32 v133, v133, v157
    v_mul_f32 v134, v134, v158
    v_mul_f32 v135, v135, v159
    v_cvt_pk_bf16_f32 v136, v128, v129
    v_cvt_pk_bf16_f32 v137, v130, v131
    v_cvt_pk_bf16_f32 v138, v132, v133
    v_cvt_pk_bf16_f32 v139, v134, v135
    global_store_dwordx4 v14, v[136:139], s[40:41] offset:2560 sc1
    s_setprio 0
    s_mov_b32 s59, 0
k_c2_l:
    s_waitcnt lgkmcnt(0)
    s_cmp_eq_u32 s27, 14
    s_cbranch_scc1 k_c2_d
    s_add_u32 s59, s59, 1
    s_sleep 1
    s_cmp_lt_u32 s59, 256
    s_cbranch_scc0 k_c2_v
    s_load_dword s27, s[28:29], 4 glc
    s_branch k_c2_l
k_c2_v:
    v_mov_b32 v15, 0
    global_load_dword v15, v15, s[28:29] offset:4 sc1
    s_waitcnt vmcnt(0)
    v_readfirstlane_b32 s27, v15
    s_cmp_lt_u32 s59, 40000
    s_cbranch_scc1 k_c2_l
k_c2_d:
    s_waitcnt vmcnt(28)
    v_add_u32 v128, 81920, v164
    v_add_u32 v129, 81920, v165
    v_add_u32 v130, 81920, v166
    v_add_u32 v131, 81920, v167
    ds_read_b64_tr_b16 v[172:173], v128 offset:0
    ds_read_b64_tr_b16 v[174:175], v128 offset:1024
    ds_read_b64_tr_b16 v[176:177], v129 offset:0
    ds_read_b64_tr_b16 v[178:179], v129 offset:1024
    ds_read_b64_tr_b16 v[180:181], v130 offset:0
    ds_read_b64_tr_b16 v[182:183], v130 offset:1024
    ds_read_b64_tr_b16 v[184:185], v131 offset:0
    ds_read_b64_tr_b16 v[186:187], v131 offset:1024
    buffer_load_dwordx4 v[204:207], v10, s[16:19], s4 offen offset:0 sc1
    buffer_load_dwordx4 v[208:211], v10, s[16:19], s4 offen offset:1024 sc1
    buffer_load_dwordx4 v[212:215], v10, s[16:19], s4 offen offset:2048 sc1
    buffer_load_dwordx4 v[216:219], v10, s[16:19], s4 offen offset:3072 sc1
    buffer_load_dwordx4 v[220:223], v10, s[16:19], s5 offen offset:0 sc1
    buffer_load_dwordx4 v[224:227], v10, s[16:19], s5 offen offset:1024 sc1
    buffer_load_dwordx4 v[228:231], v10, s[16:19], s5 offen offset:2048 sc1
    buffer_load_dwordx4 v[232:235], v10, s[16:19], s5 offen offset:3072 sc1
    s_waitcnt vmcnt(8)
    v_mov_b32 v2, 81616
    v_mov_b32 v3, 1
    s_mov_b64 exec, 1
    ds_add_rtn_u32 v4, v2, v3
    s_waitcnt lgkmcnt(0)
    v_readfirstlane_b32 s58, v4
    s_mov_b64 exec, -1
    s_cmp_eq_u32 s58, 3
    s_cbranch_scc0 k_s3
    s_lshl_b32 s13, s10, 1
    s_and_b32 s58, s13, 3
    s_lshl_b32 s58, s58, 3
    s_lshr_b32 s13, s13, 2
    s_add_u32 s13, s13, s58
    s_lshl_b32 s13, s13, 7
    s_add_u32 s13, s13, 16842752
    s_add_u32 s44, s40, s13
    s_addc_u32 s45, s41, 0
    s_mov_b32 s46, 1
    s_atomic_add s46, s[44:45], 8
    s_atomic_add s46, s[44:45], 1032
    s_atomic_add s46, s[44:45], 4104
    s_atomic_add s46, s[44:45], 5128
    s_atomic_add s46, s[44:45], 8200
    s_atomic_add s46, s[44:45], 9224
    s_atomic_add s46, s[44:45], 12296
    s_atomic_add s46, s[44:45], 13320
    s_atomic_add s46, s[44:45], 16392
    s_atomic_add s46, s[44:45], 17416
    s_atomic_add s46, s[44:45], 20488
    s_atomic_add s46, s[44:45], 21512
    s_atomic_add s46, s[44:45], 24584
    s_atomic_add s46, s[44:45], 25608
k_s3:
    buffer_load_dwordx4 v[236:239], v10, s[16:19], s6 offen offset:0 sc1
    buffer_load_dwordx4 v[240:243], v10, s[16:19], s6 offen offset:1024 sc1
    buffer_load_dwordx4 v[244:247], v10, s[16:19], s6 offen offset:2048 sc1
    buffer_load_dwordx4 v[248:251], v10, s[16:19], s6 offen offset:3072 sc1
    s_add_u32 m0, s14, 147456
    s_add_u32 s32, s32, 57344
    buffer_load_dwordx4 v160, s[20:23], s32 offen offset:0 lds
    buffer_load_dwordx4 v161, s[20:23], s32 offen offset:1024 lds
    buffer_load_dwordx4 v162, s[20:23], s32 offen offset:2048 lds
    buffer_load_dwordx4 v163, s[20:23], s32 offen offset:3072 lds
    s_waitcnt vmcnt(12) lgkmcnt(0)
    v_mfma_f32_16x16x32_bf16 v[16:19], v[172:175], v[204:207], 0
    v_add_u32 v128, 131072, v164
    buffer_load_dwordx4 v[80:83], v10, s[16:19], s39 offen offset:0 sc1
    v_mfma_f32_16x16x32_bf16 v[20:23], v[172:175], v[208:211], 0
    v_add_u32 v129, 131072, v165
    v_mfma_f32_16x16x32_bf16 v[24:27], v[172:175], v[212:215], 0
    v_add_u32 v130, 131072, v166
    buffer_load_dwordx4 v[84:87], v10, s[16:19], s39 offen offset:1024 sc1
    v_mfma_f32_16x16x32_bf16 v[28:31], v[172:175], v[216:219], 0
    v_add_u32 v131, 131072, v167
    v_mfma_f32_16x16x32_bf16 v[32:35], v[176:179], v[204:207], 0
    ds_read_b64_tr_b16 v[188:189], v128 offset:0
    buffer_load_dwordx4 v[88:91], v10, s[16:19], s39 offen offset:2048 sc1
    v_mfma_f32_16x16x32_bf16 v[36:39], v[176:179], v[208:211], 0
    ds_read_b64_tr_b16 v[190:191], v128 offset:1024
    v_mfma_f32_16x16x32_bf16 v[40:43], v[176:179], v[212:215], 0
    ds_read_b64_tr_b16 v[192:193], v129 offset:0
    buffer_load_dwordx4 v[92:95], v10, s[16:19], s39 offen offset:3072 sc1
    v_mfma_f32_16x16x32_bf16 v[44:47], v[176:179], v[216:219], 0
    ds_read_b64_tr_b16 v[194:195], v129 offset:1024
    v_mfma_f32_16x16x32_bf16 v[48:51], v[180:183], v[204:207], 0
    ds_read_b64_tr_b16 v[196:197], v130 offset:0
    s_add_u32 m0, s14, 81920
    s_add_u32 s33, s33, 57344
    buffer_load_dwordx4 v160, s[20:23], s33 offen offset:0 lds
    v_mfma_f32_16x16x32_bf16 v[52:55], v[180:183], v[208:211], 0
    ds_read_b64_tr_b16 v[198:199], v130 offset:1024
    v_mfma_f32_16x16x32_bf16 v[56:59], v[180:183], v[212:215], 0
    ds_read_b64_tr_b16 v[200:201], v131 offset:0
    buffer_load_dwordx4 v161, s[20:23], s33 offen offset:1024 lds
    v_mfma_f32_16x16x32_bf16 v[60:63], v[180:183], v[216:219], 0
    ds_read_b64_tr_b16 v[202:203], v131 offset:1024
    v_mfma_f32_16x16x32_bf16 v[64:67], v[184:187], v[204:207], 0
    buffer_load_dwordx4 v162, s[20:23], s33 offen offset:2048 lds
    v_mfma_f32_16x16x32_bf16 v[68:71], v[184:187], v[208:211], 0
    v_mfma_f32_16x16x32_bf16 v[72:75], v[184:187], v[212:215], 0
    buffer_load_dwordx4 v163, s[20:23], s33 offen offset:3072 lds
    v_mfma_f32_16x16x32_bf16 v[76:79], v[184:187], v[216:219], 0
    s_waitcnt vmcnt(16) lgkmcnt(0)
    v_mfma_f32_16x16x32_bf16 v[16:19], v[188:191], v[220:223], v[16:19]
    v_add_u32 v128, 32768, v164
    buffer_load_dwordx4 v[96:99], v10, s[16:19], s0 offen offset:0 sc1
    v_mfma_f32_16x16x32_bf16 v[20:23], v[188:191], v[224:227], v[20:23]
    v_add_u32 v129, 32768, v165
    v_mfma_f32_16x16x32_bf16 v[24:27], v[188:191], v[228:231], v[24:27]
    v_add_u32 v130, 32768, v166
    buffer_load_dwordx4 v[100:103], v10, s[16:19], s0 offen offset:1024 sc1
    v_mfma_f32_16x16x32_bf16 v[28:31], v[188:191], v[232:235], v[28:31]
    v_add_u32 v131, 32768, v167
    v_mfma_f32_16x16x32_bf16 v[32:35], v[192:195], v[220:223], v[32:35]
    ds_read_b64_tr_b16 v[172:173], v128 offset:0
    buffer_load_dwordx4 v[104:107], v10, s[16:19], s0 offen offset:2048 sc1
    v_mfma_f32_16x16x32_bf16 v[36:39], v[192:195], v[224:227], v[36:39]
    ds_read_b64_tr_b16 v[174:175], v128 offset:1024
    v_mfma_f32_16x16x32_bf16 v[40:43], v[192:195], v[228:231], v[40:43]
    ds_read_b64_tr_b16 v[176:177], v129 offset:0
    buffer_load_dwordx4 v[108:111], v10, s[16:19], s0 offen offset:3072 sc1
    v_mfma_f32_16x16x32_bf16 v[44:47], v[192:195], v[232:235], v[44:47]
    ds_read_b64_tr_b16 v[178:179], v129 offset:1024
    v_mfma_f32_16x16x32_bf16 v[48:51], v[196:199], v[220:223], v[48:51]
    ds_read_b64_tr_b16 v[180:181], v130 offset:0
    s_add_u32 m0, s14, 131072
    s_add_u32 s34, s34, 57344
    buffer_load_dwordx4 v160, s[20:23], s34 offen offset:0 lds
    v_mfma_f32_16x16x32_bf16 v[52:55], v[196:199], v[224:227], v[52:55]
    ds_read_b64_tr_b16 v[182:183], v130 offset:1024
    v_mfma_f32_16x16x32_bf16 v[56:59], v[196:199], v[228:231], v[56:59]
    ds_read_b64_tr_b16 v[184:185], v131 offset:0
    buffer_load_dwordx4 v161, s[20:23], s34 offen offset:1024 lds
    v_mfma_f32_16x16x32_bf16 v[60:63], v[196:199], v[232:235], v[60:63]
    ds_read_b64_tr_b16 v[186:187], v131 offset:1024
    v_mfma_f32_16x16x32_bf16 v[64:67], v[200:203], v[220:223], v[64:67]
    buffer_load_dwordx4 v162, s[20:23], s34 offen offset:2048 lds
    v_mfma_f32_16x16x32_bf16 v[68:71], v[200:203], v[224:227], v[68:71]
    v_mfma_f32_16x16x32_bf16 v[72:75], v[200:203], v[228:231], v[72:75]
    buffer_load_dwordx4 v163, s[20:23], s34 offen offset:3072 lds
    v_mfma_f32_16x16x32_bf16 v[76:79], v[200:203], v[232:235], v[76:79]
    s_waitcnt vmcnt(20) lgkmcnt(0)
    v_mfma_f32_16x16x32_bf16 v[16:19], v[172:175], v[236:239], v[16:19]
    v_add_u32 v128, 0, v164
    buffer_load_dwordx4 v[112:115], v10, s[16:19], s1 offen offset:0 sc1
    v_mfma_f32_16x16x32_bf16 v[20:23], v[172:175], v[240:243], v[20:23]
    v_add_u32 v129, 0, v165
    v_mfma_f32_16x16x32_bf16 v[24:27], v[172:175], v[244:247], v[24:27]
    v_add_u32 v130, 0, v166
    buffer_load_dwordx4 v[116:119], v10, s[16:19], s1 offen offset:1024 sc1
    v_mfma_f32_16x16x32_bf16 v[28:31], v[172:175], v[248:251], v[28:31]
    v_add_u32 v131, 0, v167
    v_mfma_f32_16x16x32_bf16 v[32:35], v[176:179], v[236:239], v[32:35]
    ds_read_b64_tr_b16 v[188:189], v128 offset:0
    buffer_load_dwordx4 v[120:123], v10, s[16:19], s1 offen offset:2048 sc1
    v_mfma_f32_16x16x32_bf16 v[36:39], v[176:179], v[240:243], v[36:39]
    ds_read_b64_tr_b16 v[190:191], v128 offset:1024
    v_mfma_f32_16x16x32_bf16 v[40:43], v[176:179], v[244:247], v[40:43]
    ds_read_b64_tr_b16 v[192:193], v129 offset:0
    buffer_load_dwordx4 v[124:127], v10, s[16:19], s1 offen offset:3072 sc1
    v_mfma_f32_16x16x32_bf16 v[44:47], v[176:179], v[248:251], v[44:47]
    ds_read_b64_tr_b16 v[194:195], v129 offset:1024
    v_mfma_f32_16x16x32_bf16 v[48:51], v[180:183], v[236:239], v[48:51]
    ds_read_b64_tr_b16 v[196:197], v130 offset:0
    s_add_u32 m0, s14, 32768
    s_add_u32 s35, s35, 57344
    buffer_load_dwordx4 v160, s[20:23], s35 offen offset:0 lds
    v_mfma_f32_16x16x32_bf16 v[52:55], v[180:183], v[240:243], v[52:55]
    ds_read_b64_tr_b16 v[198:199], v130 offset:1024
    v_mfma_f32_16x16x32_bf16 v[56:59], v[180:183], v[244:247], v[56:59]
    ds_read_b64_tr_b16 v[200:201], v131 offset:0
    buffer_load_dwordx4 v161, s[20:23], s35 offen offset:1024 lds
    v_mfma_f32_16x16x32_bf16 v[60:63], v[180:183], v[248:251], v[60:63]
    ds_read_b64_tr_b16 v[202:203], v131 offset:1024
    v_mfma_f32_16x16x32_bf16 v[64:67], v[184:187], v[236:239], v[64:67]
    buffer_load_dwordx4 v162, s[20:23], s35 offen offset:2048 lds
    v_mfma_f32_16x16x32_bf16 v[68:71], v[184:187], v[240:243], v[68:71]
    v_mfma_f32_16x16x32_bf16 v[72:75], v[184:187], v[244:247], v[72:75]
    buffer_load_dwordx4 v163, s[20:23], s35 offen offset:3072 lds
    v_mfma_f32_16x16x32_bf16 v[76:79], v[184:187], v[248:251], v[76:79]
    s_waitcnt vmcnt(20) lgkmcnt(0)
    v_mfma_f32_16x16x32_bf16 v[16:19], v[188:191], v[80:83], v[16:19]
    v_add_u32 v128, 16384, v164
    buffer_load_dwordx4 v[144:147], v10, s[16:19], s60 offen offset:0 sc1
    v_mfma_f32_16x16x32_bf16 v[20:23], v[188:191], v[84:87], v[20:23]
    v_add_u32 v129, 16384, v165
    v_mfma_f32_16x16x32_bf16 v[24:27], v[188:191], v[88:91], v[24:27]
    v_add_u32 v130, 16384, v166
    v_mfma_f32_16x16x32_bf16 v[28:31], v[188:191], v[92:95], v[28:31]
    v_add_u32 v131, 16384, v167
    v_mfma_f32_16x16x32_bf16 v[32:35], v[192:195], v[80:83], v[32:35]
    ds_read_b64_tr_b16 v[172:173], v128 offset:0
    buffer_load_dwordx4 v[148:151], v10, s[16:19], s60 offen offset:1024 sc1
    v_mfma_f32_16x16x32_bf16 v[36:39], v[192:195], v[84:87], v[36:39]
    ds_read_b64_tr_b16 v[174:175], v128 offset:1024
    v_mfma_f32_16x16x32_bf16 v[40:43], v[192:195], v[88:91], v[40:43]
    ds_read_b64_tr_b16 v[176:177], v129 offset:0
    v_mfma_f32_16x16x32_bf16 v[44:47], v[192:195], v[92:95], v[44:47]
    ds_read_b64_tr_b16 v[178:179], v129 offset:1024
    v_mfma_f32_16x16x32_bf16 v[48:51], v[196:199], v[80:83], v[48:51]
    ds_read_b64_tr_b16 v[180:181], v130 offset:0
    buffer_load_dwordx4 v[152:155], v10, s[16:19], s60 offen offset:2048 sc1
    v_mfma_f32_16x16x32_bf16 v[52:55], v[196:199], v[84:87], v[52:55]
    ds_read_b64_tr_b16 v[182:183], v130 offset:1024
    v_mfma_f32_16x16x32_bf16 v[56:59], v[196:199], v[88:91], v[56:59]
    ds_read_b64_tr_b16 v[184:185], v131 offset:0
    v_mfma_f32_16x16x32_bf16 v[60:63], v[196:199], v[92:95], v[60:63]
    ds_read_b64_tr_b16 v[186:187], v131 offset:1024
    v_mfma_f32_16x16x32_bf16 v[64:67], v[200:203], v[80:83], v[64:67]
    buffer_load_dwordx4 v[156:159], v10, s[16:19], s60 offen offset:3072 sc1
    v_mfma_f32_16x16x32_bf16 v[68:71], v[200:203], v[84:87], v[68:71]
    v_mfma_f32_16x16x32_bf16 v[72:75], v[200:203], v[88:91], v[72:75]
    v_mfma_f32_16x16x32_bf16 v[76:79], v[200:203], v[92:95], v[76:79]
    s_waitcnt vmcnt(16) lgkmcnt(0)
    v_mfma_f32_16x16x32_bf16 v[16:19], v[172:175], v[96:99], v[16:19]
    s_load_dword s27, s[28:29], 8 glc
    s_add_u32 m0, s14, 0
    s_add_u32 s36, s36, 57344
    buffer_load_dwordx4 v160, s[20:23], s36 offen offset:0 lds
    v_mfma_f32_16x16x32_bf16 v[20:23], v[172:175], v[100:103], v[20:23]
    v_add_u32 v128, 98304, v164
    v_mfma_f32_16x16x32_bf16 v[24:27], v[172:175], v[104:107], v[24:27]
    v_add_u32 v129, 98304, v165
    v_mfma_f32_16x16x32_bf16 v[28:31], v[172:175], v[108:111], v[28:31]
    v_add_u32 v130, 98304, v166
    v_mfma_f32_16x16x32_bf16 v[32:35], v[176:179], v[96:99], v[32:35]
    v_add_u32 v131, 98304, v167
    buffer_load_dwordx4 v161, s[20:23], s36 offen offset:1024 lds
    v_mfma_f32_16x16x32_bf16 v[36:39], v[176:179], v[100:103], v[36:39]
    ds_read_b64_tr_b16 v[188:189], v128 offset:0
    v_mfma_f32_16x16x32_bf16 v[40:43], v[176:179], v[104:107], v[40:43]
    ds_read_b64_tr_b16 v[190:191], v128 offset:1024
    v_mfma_f32_16x16x32_bf16 v[44:47], v[176:179], v[108:111], v[44:47]
    ds_read_b64_tr_b16 v[192:193], v129 offset:0
    v_mfma_f32_16x16x32_bf16 v[48:51], v[180:183], v[96:99], v[48:51]
    ds_read_b64_tr_b16 v[194:195], v129 offset:1024
    buffer_load_dwordx4 v162, s[20:23], s36 offen offset:2048 lds
    v_mfma_f32_16x16x32_bf16 v[52:55], v[180:183], v[100:103], v[52:55]
    ds_read_b64_tr_b16 v[196:197], v130 offset:0
    v_mfma_f32_16x16x32_bf16 v[56:59], v[180:183], v[104:107], v[56:59]
    ds_read_b64_tr_b16 v[198:199], v130 offset:1024
    v_mfma_f32_16x16x32_bf16 v[60:63], v[180:183], v[108:111], v[60:63]
    ds_read_b64_tr_b16 v[200:201], v131 offset:0
    v_mfma_f32_16x16x32_bf16 v[64:67], v[184:187], v[96:99], v[64:67]
    ds_read_b64_tr_b16 v[202:203], v131 offset:1024
    buffer_load_dwordx4 v163, s[20:23], s36 offen offset:3072 lds
    v_mfma_f32_16x16x32_bf16 v[68:71], v[184:187], v[100:103], v[68:71]
    v_mfma_f32_16x16x32_bf16 v[72:75], v[184:187], v[104:107], v[72:75]
    v_mfma_f32_16x16x32_bf16 v[76:79], v[184:187], v[108:111], v[76:79]
    s_mov_b32 s59, 0
k_c3_l:
    s_waitcnt lgkmcnt(0)
    s_cmp_eq_u32 s27, 14
    s_cbranch_scc1 k_c3_d
    s_add_u32 s59, s59, 1
    s_sleep 1
    s_cmp_lt_u32 s59, 256
    s_cbranch_scc0 k_c3_v
    s_load_dword s27, s[28:29], 8 glc
    s_branch k_c3_l
k_c3_v:
    v_mov_b32 v15, 0
    global_load_dword v15, v15, s[28:29] offset:8 sc1
    s_waitcnt vmcnt(0)
    v_readfirstlane_b32 s27, v15
    s_cmp_lt_u32 s59, 40000
    s_cbranch_scc1 k_c3_l
k_c3_d:
    s_waitcnt vmcnt(12) lgkmcnt(0)
    v_mfma_f32_16x16x32_bf16 v[16:19], v[188:191], v[112:115], v[16:19]
    v_add_u32 v128, 49152, v164
    s_add_u32 s4, s4, 114688
    buffer_load_dwordx4 v[204:207], v10, s[16:19], s4 offen offset:0 sc1
    v_mfma_f32_16x16x32_bf16 v[20:23], v[188:191], v[116:119], v[20:23]
    v_add_u32 v129, 49152, v165
    v_mfma_f32_16x16x32_bf16 v[24:27], v[188:191], v[120:123], v[24:27]
    v_add_u32 v130, 49152, v166
    v_mfma_f32_16x16x32_bf16 v[28:31], v[188:191], v[124:127], v[28:31]
    v_add_u32 v131, 49152, v167
    v_mfma_f32_16x16x32_bf16 v[32:35], v[192:195], v[112:115], v[32:35]
    ds_read_b64_tr_b16 v[172:173], v128 offset:0
    buffer_load_dwordx4 v[208:211], v10, s[16:19], s4 offen offset:1024 sc1
    v_mfma_f32_16x16x32_bf16 v[36:39], v[192:195], v[116:119], v[36:39]
    ds_read_b64_tr_b16 v[174:175], v128 offset:1024
    v_mfma_f32_16x16x32_bf16 v[40:43], v[192:195], v[120:123], v[40:43]
    ds_read_b64_tr_b16 v[176:177], v129 offset:0
    v_mfma_f32_16x16x32_bf16 v[44:47], v[192:195], v[124:127], v[44:47]
    ds_read_b64_tr_b16 v[178:179], v129 offset:1024
    v_mfma_f32_16x16x32_bf16 v[48:51], v[196:199], v[112:115], v[48:51]
    ds_read_b64_tr_b16 v[180:181], v130 offset:0
    buffer_load_dwordx4 v[212:215], v10, s[16:19], s4 offen offset:2048 sc1
    v_mfma_f32_16x16x32_bf16 v[52:55], v[196:199], v[116:119], v[52:55]
    ds_read_b64_tr_b16 v[182:183], v130 offset:1024
    v_mfma_f32_16x16x32_bf16 v[56:59], v[196:199], v[120:123], v[56:59]
    ds_read_b64_tr_b16 v[184:185], v131 offset:0
    v_mfma_f32_16x16x32_bf16 v[60:63], v[196:199], v[124:127], v[60:63]
    ds_read_b64_tr_b16 v[186:187], v131 offset:1024
    v_mfma_f32_16x16x32_bf16 v[64:67], v[200:203], v[112:115], v[64:67]
    buffer_load_dwordx4 v[216:219], v10, s[16:19], s4 offen offset:3072 sc1
    v_mfma_f32_16x16x32_bf16 v[68:71], v[200:203], v[116:119], v[68:71]
    v_mfma_f32_16x16x32_bf16 v[72:75], v[200:203], v[120:123], v[72:75]
    v_mfma_f32_16x16x32_bf16 v[76:79], v[200:203], v[124:127], v[76:79]
    s_waitcnt vmcnt(8) lgkmcnt(0)
    v_mfma_f32_16x16x32_bf16 v[16:19], v[172:175], v[144:147], v[16:19]
    v_add_u32 v128, 147456, v164
    s_add_u32 s5, s5, 114688
    buffer_load_dwordx4 v[220:223], v10, s[16:19], s5 offen offset:0 sc1
    v_mfma_f32_16x16x32_bf16 v[20:23], v[172:175], v[148:151], v[20:23]
    v_add_u32 v129, 147456, v165
    v_mfma_f32_16x16x32_bf16 v[24:27], v[172:175], v[152:155], v[24:27]
    v_add_u32 v130, 147456, v166
    buffer_load_dwordx4 v[224:227], v10, s[16:19], s5 offen offset:1024 sc1
    v_mfma_f32_16x16x32_bf16 v[28:31], v[172:175], v[156:159], v[28:31]
    v_add_u32 v131, 147456, v167
    v_mfma_f32_16x16x32_bf16 v[32:35], v[176:179], v[144:147], v[32:35]
    ds_read_b64_tr_b16 v[188:189], v128 offset:0
    buffer_load_dwordx4 v[228:231], v10, s[16:19], s5 offen offset:2048 sc1
    v_mfma_f32_16x16x32_bf16 v[36:39], v[176:179], v[148:151], v[36:39]
    ds_read_b64_tr_b16 v[190:191], v128 offset:1024
    v_mfma_f32_16x16x32_bf16 v[40:43], v[176:179], v[152:155], v[40:43]
    ds_read_b64_tr_b16 v[192:193], v129 offset:0
    buffer_load_dwordx4 v[232:235], v10, s[16:19], s5 offen offset:3072 sc1
    v_mfma_f32_16x16x32_bf16 v[44:47], v[176:179], v[156:159], v[44:47]
    ds_read_b64_tr_b16 v[194:195], v129 offset:1024
    v_mfma_f32_16x16x32_bf16 v[48:51], v[180:183], v[144:147], v[48:51]
    ds_read_b64_tr_b16 v[196:197], v130 offset:0
    s_add_u32 m0, s14, 16384
    s_add_u32 s37, s37, 57344
    buffer_load_dwordx4 v160, s[20:23], s37 offen offset:0 lds
    v_mfma_f32_16x16x32_bf16 v[52:55], v[180:183], v[148:151], v[52:55]
    ds_read_b64_tr_b16 v[198:199], v130 offset:1024
    v_mfma_f32_16x16x32_bf16 v[56:59], v[180:183], v[152:155], v[56:59]
    ds_read_b64_tr_b16 v[200:201], v131 offset:0
    buffer_load_dwordx4 v161, s[20:23], s37 offen offset:1024 lds
    v_mfma_f32_16x16x32_bf16 v[60:63], v[180:183], v[156:159], v[60:63]
    ds_read_b64_tr_b16 v[202:203], v131 offset:1024
    v_mfma_f32_16x16x32_bf16 v[64:67], v[184:187], v[144:147], v[64:67]
    buffer_load_dwordx4 v162, s[20:23], s37 offen offset:2048 lds
    v_mfma_f32_16x16x32_bf16 v[68:71], v[184:187], v[148:151], v[68:71]
    v_mfma_f32_16x16x32_bf16 v[72:75], v[184:187], v[152:155], v[72:75]
    buffer_load_dwordx4 v163, s[20:23], s37 offen offset:3072 lds
    v_mfma_f32_16x16x32_bf16 v[76:79], v[184:187], v[156:159], v[76:79]
    s_waitcnt vmcnt(8) lgkmcnt(0)
    v_mfma_f32_16x16x32_bf16 v[16:19], v[188:191], v[204:207], v[16:19]
    v_add_u32 v128, 81920, v164
    s_add_u32 s6, s6, 114688
    buffer_load_dwordx4 v[236:239], v10, s[16:19], s6 offen offset:0 sc1
    v_mfma_f32_16x16x32_bf16 v[20:23], v[188:191], v[208:211], v[20:23]
    v_add_u32 v129, 81920, v165
    v_mfma_f32_16x16x32_bf16 v[24:27], v[188:191], v[212:215], v[24:27]
    v_add_u32 v130, 81920, v166
    buffer_load_dwordx4 v[240:243], v10, s[16:19], s6 offen offset:1024 sc1
    v_mfma_f32_16x16x32_bf16 v[28:31], v[188:191], v[216:219], v[28:31]
    v_add_u32 v131, 81920, v167
    v_mfma_f32_16x16x32_bf16 v[32:35], v[192:195], v[204:207], v[32:35]
    ds_read_b64_tr_b16 v[172:173], v128 offset:0
    buffer_load_dwordx4 v[244:247], v10, s[16:19], s6 offen offset:2048 sc1
    v_mfma_f32_16x16x32_bf16 v[36:39], v[192:195], v[208:211], v[36:39]
    ds_read_b64_tr_b16 v[174:175], v128 offset:1024
    v_mfma_f32_16x16x32_bf16 v[40:43], v[192:195], v[212:215], v[40:43]
    ds_read_b64_tr_b16 v[176:177], v129 offset:0
    buffer_load_dwordx4 v[248:251], v10, s[16:19], s6 offen offset:3072 sc1
    v_mfma_f32_16x16x32_bf16 v[44:47], v[192:195], v[216:219], v[44:47]
    ds_read_b64_tr_b16 v[178:179], v129 offset:1024
    v_mfma_f32_16x16x32_bf16 v[48:51], v[196:199], v[204:207], v[48:51]
    ds_read_b64_tr_b16 v[180:181], v130 offset:0
    s_add_u32 m0, s14, 98304
    s_add_u32 s38, s38, 57344
    buffer_load_dwordx4 v160, s[20:23], s38 offen offset:0 lds
    v_mfma_f32_16x16x32_bf16 v[52:55], v[196:199], v[208:211], v[52:55]
    ds_read_b64_tr_b16 v[182:183], v130 offset:1024
    v_mfma_f32_16x16x32_bf16 v[56:59], v[196:199], v[212:215], v[56:59]
    ds_read_b64_tr_b16 v[184:185], v131 offset:0
    buffer_load_dwordx4 v161, s[20:23], s38 offen offset:1024 lds
    v_mfma_f32_16x16x32_bf16 v[60:63], v[196:199], v[216:219], v[60:63]
    ds_read_b64_tr_b16 v[186:187], v131 offset:1024
    v_mfma_f32_16x16x32_bf16 v[64:67], v[200:203], v[204:207], v[64:67]
    buffer_load_dwordx4 v162, s[20:23], s38 offen offset:2048 lds
    v_mfma_f32_16x16x32_bf16 v[68:71], v[200:203], v[208:211], v[68:71]
    v_mfma_f32_16x16x32_bf16 v[72:75], v[200:203], v[212:215], v[72:75]
    buffer_load_dwordx4 v163, s[20:23], s38 offen offset:3072 lds
    v_mfma_f32_16x16x32_bf16 v[76:79], v[200:203], v[216:219], v[76:79]
    s_waitcnt vmcnt(12) lgkmcnt(0)
    v_mfma_f32_16x16x32_bf16 v[16:19], v[172:175], v[220:223], v[16:19]
    v_add_u32 v128, 131072, v164
    s_add_u32 s39, s39, 114688
    buffer_load_dwordx4 v[80:83], v10, s[16:19], s39 offen offset:0 sc1
    v_mfma_f32_16x16x32_bf16 v[20:23], v[172:175], v[224:227], v[20:23]
    v_add_u32 v129, 131072, v165
    v_mfma_f32_16x16x32_bf16 v[24:27], v[172:175], v[228:231], v[24:27]
    v_add_u32 v130, 131072, v166
    v_mfma_f32_16x16x32_bf16 v[28:31], v[172:175], v[232:235], v[28:31]
    v_add_u32 v131, 131072, v167
    v_mfma_f32_16x16x32_bf16 v[32:35], v[176:179], v[220:223], v[32:35]
    ds_read_b64_tr_b16 v[188:189], v128 offset:0
    buffer_load_dwordx4 v[84:87], v10, s[16:19], s39 offen offset:1024 sc1
    v_mfma_f32_16x16x32_bf16 v[36:39], v[176:179], v[224:227], v[36:39]
    ds_read_b64_tr_b16 v[190:191], v128 offset:1024
    v_mfma_f32_16x16x32_bf16 v[40:43], v[176:179], v[228:231], v[40:43]
    ds_read_b64_tr_b16 v[192:193], v129 offset:0
    v_mfma_f32_16x16x32_bf16 v[44:47], v[176:179], v[232:235], v[44:47]
    ds_read_b64_tr_b16 v[194:195], v129 offset:1024
    v_mfma_f32_16x16x32_bf16 v[48:51], v[180:183], v[220:223], v[48:51]
    ds_read_b64_tr_b16 v[196:197], v130 offset:0
    buffer_load_dwordx4 v[88:91], v10, s[16:19], s39 offen offset:2048 sc1
    v_mfma_f32_16x16x32_bf16 v[52:55], v[180:183], v[224:227], v[52:55]
    ds_read_b64_tr_b16 v[198:199], v130 offset:1024
    v_mfma_f32_16x16x32_bf16 v[56:59], v[180:183], v[228:231], v[56:59]
    ds_read_b64_tr_b16 v[200:201], v131 offset:0
    v_mfma_f32_16x16x32_bf16 v[60:63], v[180:183], v[232:235], v[60:63]
    ds_read_b64_tr_b16 v[202:203], v131 offset:1024
    v_mfma_f32_16x16x32_bf16 v[64:67], v[184:187], v[220:223], v[64:67]
    buffer_load_dwordx4 v[92:95], v10, s[16:19], s39 offen offset:3072 sc1
    v_mfma_f32_16x16x32_bf16 v[68:71], v[184:187], v[224:227], v[68:71]
    v_mfma_f32_16x16x32_bf16 v[72:75], v[184:187], v[228:231], v[72:75]
    v_mfma_f32_16x16x32_bf16 v[76:79], v[184:187], v[232:235], v[76:79]
    s_waitcnt vmcnt(8) lgkmcnt(0)
    v_mfma_f32_16x16x32_bf16 v[16:19], v[188:191], v[236:239], v[16:19]
    v_add_u32 v128, 32768, v164
    s_add_u32 s0, s0, 114688
    buffer_load_dwordx4 v[96:99], v10, s[16:19], s0 offen offset:0 sc1
    v_mfma_f32_16x16x32_bf16 v[20:23], v[188:191], v[240:243], v[20:23]
    v_add_u32 v129, 32768, v165
    v_mfma_f32_16x16x32_bf16 v[24:27], v[188:191], v[244:247], v[24:27]
    v_add_u32 v130, 32768, v166
    v_mfma_f32_16x16x32_bf16 v[28:31], v[188:191], v[248:251], v[28:31]
    v_add_u32 v131, 32768, v167
    v_mfma_f32_16x16x32_bf16 v[32:35], v[192:195], v[236:239], v[32:35]
    ds_read_b64_tr_b16 v[172:173], v128 offset:0
    buffer_load_dwordx4 v[100:103], v10, s[16:19], s0 offen offset:1024 sc1
    v_mfma_f32_16x16x32_bf16 v[36:39], v[192:195], v[240:243], v[36:39]
    ds_read_b64_tr_b16 v[174:175], v128 offset:1024
    v_mfma_f32_16x16x32_bf16 v[40:43], v[192:195], v[244:247], v[40:43]
    ds_read_b64_tr_b16 v[176:177], v129 offset:0
    v_mfma_f32_16x16x32_bf16 v[44:47], v[192:195], v[248:251], v[44:47]
    ds_read_b64_tr_b16 v[178:179], v129 offset:1024
    v_mfma_f32_16x16x32_bf16 v[48:51], v[196:199], v[236:239], v[48:51]
    ds_read_b64_tr_b16 v[180:181], v130 offset:0
    buffer_load_dwordx4 v[104:107], v10, s[16:19], s0 offen offset:2048 sc1
    v_mfma_f32_16x16x32_bf16 v[52:55], v[196:199], v[240:243], v[52:55]
    ds_read_b64_tr_b16 v[182:183], v130 offset:1024
    v_mfma_f32_16x16x32_bf16 v[56:59], v[196:199], v[244:247], v[56:59]
    ds_read_b64_tr_b16 v[184:185], v131 offset:0
    v_mfma_f32_16x16x32_bf16 v[60:63], v[196:199], v[248:251], v[60:63]
    ds_read_b64_tr_b16 v[186:187], v131 offset:1024
    v_mfma_f32_16x16x32_bf16 v[64:67], v[200:203], v[236:239], v[64:67]
    buffer_load_dwordx4 v[108:111], v10, s[16:19], s0 offen offset:3072 sc1
    v_mfma_f32_16x16x32_bf16 v[68:71], v[200:203], v[240:243], v[68:71]
    v_mfma_f32_16x16x32_bf16 v[72:75], v[200:203], v[244:247], v[72:75]
    v_mfma_f32_16x16x32_bf16 v[76:79], v[200:203], v[248:251], v[76:79]
    s_waitcnt vmcnt(4) lgkmcnt(0)
    v_mfma_f32_16x16x32_bf16 v[16:19], v[172:175], v[80:83], v[16:19]
    v_add_u32 v128, 0, v164
    s_add_u32 s1, s1, 114688
    buffer_load_dwordx4 v[112:115], v10, s[16:19], s1 offen offset:0 sc1
    v_and_b32 v132, 15, v1
    v_mfma_f32_16x16x32_bf16 v[20:23], v[172:175], v[84:87], v[20:23]
    v_add_u32 v129, 0, v165
    v_lshrrev_b32 v133, 4, v1
    v_mfma_f32_16x16x32_bf16 v[24:27], v[172:175], v[88:91], v[24:27]
    v_add_u32 v130, 0, v166
    v_xor_b32 v133, v133, v132
    v_mfma_f32_16x16x32_bf16 v[28:31], v[172:175], v[92:95], v[28:31]
    v_add_u32 v131, 0, v167
    v_lshlrev_b32 v133, 4, v133
    v_mfma_f32_16x16x32_bf16 v[32:35], v[176:179], v[80:83], v[32:35]
    ds_read_b64_tr_b16 v[188:189], v128 offset:0
    buffer_load_dwordx4 v[116:119], v10, s[16:19], s1 offen offset:1024 sc1
    v_lshl_add_u32 v132, v132, 8, v133
    v_mfma_f32_16x16x32_bf16 v[36:39], v[176:179], v[84:87], v[36:39]
    ds_read_b64_tr_b16 v[190:191], v128 offset:1024
    v_add_u32 v132, s14, v132
    v_mfma_f32_16x16x32_bf16 v[40:43], v[176:179], v[88:91], v[40:43]
    ds_read_b64_tr_b16 v[192:193], v129 offset:0
    v_xor_b32 v133, 64, v132
    v_mfma_f32_16x16x32_bf16 v[44:47], v[176:179], v[92:95], v[44:47]
    ds_read_b64_tr_b16 v[194:195], v129 offset:1024
    v_xor_b32 v134, 128, v132
    v_mfma_f32_16x16x32_bf16 v[48:51], v[180:183], v[80:83], v[48:51]
    ds_read_b64_tr_b16 v[196:197], v130 offset:0
    buffer_load_dwordx4 v[120:123], v10, s[16:19], s1 offen offset:2048 sc1
    v_xor_b32 v135, 192, v132
    v_mfma_f32_16x16x32_bf16 v[52:55], v[180:183], v[84:87], v[52:55]
    ds_read_b64_tr_b16 v[198:199], v130 offset:1024
    v_mfma_f32_16x16x32_bf16 v[56:59], v[180:183], v[88:91], v[56:59]
    ds_read_b64_tr_b16 v[200:201], v131 offset:0
    v_mfma_f32_16x16x32_bf16 v[60:63], v[180:183], v[92:95], v[60:63]
    ds_read_b64_tr_b16 v[202:203], v131 offset:1024
    v_mfma_f32_16x16x32_bf16 v[64:67], v[184:187], v[80:83], v[64:67]
    buffer_load_dwordx4 v[124:127], v10, s[16:19], s1 offen offset:3072 sc1
    v_mfma_f32_16x16x32_bf16 v[68:71], v[184:187], v[84:87], v[68:71]
    v_mfma_f32_16x16x32_bf16 v[72:75], v[184:187], v[88:91], v[72:75]
    v_mfma_f32_16x16x32_bf16 v[76:79], v[184:187], v[92:95], v[76:79]
    s_waitcnt vmcnt(4) lgkmcnt(0)
    v_mfma_f32_16x16x32_bf16 v[16:19], v[188:191], v[96:99], v[16:19]
    v_add_u32 v128, 16384, v164
    s_add_u32 s60, s60, 114688
    buffer_load_dwordx4 v[144:147], v10, s[16:19], s60 offen offset:0 sc1
    s_lshr_b32 s13, s3, 1
    v_mfma_f32_16x16x32_bf16 v[20:23], v[188:191], v[100:103], v[20:23]
    v_add_u32 v129, 16384, v165
    s_and_b32 s58, s3, 1
    v_mfma_f32_16x16x32_bf16 v[24:27], v[188:191], v[104:107], v[24:27]
    v_add_u32 v130, 16384, v166
    s_lshl_b32 s58, s58, 2
    v_mfma_f32_16x16x32_bf16 v[28:31], v[188:191], v[108:111], v[28:31]
    v_add_u32 v131, 16384, v167
    v_and_b32 v2, 15, v1
    v_mfma_f32_16x16x32_bf16 v[32:35], v[192:195], v[96:99], v[32:35]
    ds_read_b64_tr_b16 v[172:173], v128 offset:0
    buffer_load_dwordx4 v[148:151], v10, s[16:19], s60 offen offset:1024 sc1
    v_lshrrev_b32 v3, 4, v1
    v_mfma_f32_16x16x32_bf16 v[36:39], v[192:195], v[100:103], v[36:39]
    ds_read_b64_tr_b16 v[174:175], v128 offset:1024
    v_add_u32 v3, s58, v3
    v_mfma_f32_16x16x32_bf16 v[40:43], v[192:195], v[104:107], v[40:43]
    ds_read_b64_tr_b16 v[176:177], v129 offset:0
    s_lshl_b32 s59, s13, 14
    v_mfma_f32_16x16x32_bf16 v[44:47], v[192:195], v[108:111], v[44:47]
    ds_read_b64_tr_b16 v[178:179], v129 offset:1024
    v_lshlrev_b32 v5, 1, v3
    v_mfma_f32_16x16x32_bf16 v[48:51], v[196:199], v[96:99], v[48:51]
    ds_read_b64_tr_b16 v[180:181], v130 offset:0
    buffer_load_dwordx4 v[152:155], v10, s[16:19], s60 offen offset:2048 sc1
    v_xor_b32 v5, v5, v2
    v_mfma_f32_16x16x32_bf16 v[52:55], v[196:199], v[100:103], v[52:55]
    ds_read_b64_tr_b16 v[182:183], v130 offset:1024
    v_lshlrev_b32 v5, 4, v5
    v_mfma_f32_16x16x32_bf16 v[56:59], v[196:199], v[104:107], v[56:59]
    ds_read_b64_tr_b16 v[184:185], v131 offset:0
    v_lshl_add_u32 v5, v2, 8, v5
    v_mfma_f32_16x16x32_bf16 v[60:63], v[196:199], v[108:111], v[60:63]
    ds_read_b64_tr_b16 v[186:187], v131 offset:1024
    v_add_u32 v5, s59, v5
    v_mfma_f32_16x16x32_bf16 v[64:67], v[200:203], v[96:99], v[64:67]
    buffer_load_dwordx4 v[156:159], v10, s[16:19], s60 offen offset:3072 sc1
    v_xor_b32 v6, 16, v5
    v_mfma_f32_16x16x32_bf16 v[68:71], v[200:203], v[100:103], v[68:71]
    s_lshl_b32 s13, s13, 4
    v_mfma_f32_16x16x32_bf16 v[72:75], v[200:203], v[104:107], v[72:75]
    v_add_u32 v2, s13, v2
    v_mfma_f32_16x16x32_bf16 v[76:79], v[200:203], v[108:111], v[76:79]
    v_lshlrev_b32 v7, 2, v2
    v_add_u32 v7, 130752, v7
    s_waitcnt vmcnt(4) lgkmcnt(0)
    v_mfma_f32_16x16x32_bf16 v[16:19], v[172:175], v[112:115], v[16:19]
    v_add_u32 v128, 98304, v164
    s_and_b32 s58, s2, 7
    v_mfma_f32_16x16x32_bf16 v[20:23], v[172:175], v[116:119], v[20:23]
    v_add_u32 v129, 98304, v165
    s_lshl_b32 s58, s58, 2
    v_mfma_f32_16x16x32_bf16 v[24:27], v[172:175], v[120:123], v[24:27]
    v_add_u32 v130, 98304, v166
    s_add_u32 s58, s58, s8
    v_mfma_f32_16x16x32_bf16 v[28:31], v[172:175], v[124:127], v[28:31]
    v_add_u32 v131, 98304, v167
    s_lshl_b32 s58, s58, 6
    v_mfma_f32_16x16x32_bf16 v[32:35], v[176:179], v[112:115], v[32:35]
    ds_read_b64_tr_b16 v[188:189], v128 offset:0
    v_add_u32 v4, s58, v2
    v_mfma_f32_16x16x32_bf16 v[36:39], v[176:179], v[116:119], v[36:39]
    ds_read_b64_tr_b16 v[190:191], v128 offset:1024
    v_mul_u32_u24 v4, 896, v4
    v_mfma_f32_16x16x32_bf16 v[40:43], v[176:179], v[120:123], v[40:43]
    ds_read_b64_tr_b16 v[192:193], v129 offset:0
    v_lshl_add_u32 v4, v3, 4, v4
    v_mfma_f32_16x16x32_bf16 v[44:47], v[176:179], v[124:127], v[44:47]
    ds_read_b64_tr_b16 v[194:195], v129 offset:1024
    s_lshl_b32 s58, s12, 7
    v_mfma_f32_16x16x32_bf16 v[48:51], v[180:183], v[112:115], v[48:51]
    ds_read_b64_tr_b16 v[196:197], v130 offset:0
    v_add_u32 v4, s58, v4
    v_mfma_f32_16x16x32_bf16 v[52:55], v[180:183], v[116:119], v[52:55]
    ds_read_b64_tr_b16 v[198:199], v130 offset:1024
    v_bfe_u32 v8, v1, 2, 2
    v_mfma_f32_16x16x32_bf16 v[56:59], v[180:183], v[120:123], v[56:59]
    ds_read_b64_tr_b16 v[200:201], v131 offset:0
    v_lshl_add_u32 v8, v3, 3, v8
    v_mfma_f32_16x16x32_bf16 v[60:63], v[180:183], v[124:127], v[60:63]
    ds_read_b64_tr_b16 v[202:203], v131 offset:1024
    v_mul_u32_u24 v8, 144, v8
    v_mfma_f32_16x16x32_bf16 v[64:67], v[184:187], v[112:115], v[64:67]
    v_and_b32 v9, 3, v1
    v_mfma_f32_16x16x32_bf16 v[68:71], v[184:187], v[116:119], v[68:71]
    v_lshl_add_u32 v8, v9, 3, v8
    v_mfma_f32_16x16x32_bf16 v[72:75], v[184:187], v[120:123], v[72:75]
    s_lshl_b32 s13, s13, 1
    v_mfma_f32_16x16x32_bf16 v[76:79], v[184:187], v[124:127], v[76:79]
    s_add_u32 s13, s13, 65536
    v_add_u32 v8, s13, v8
    s_waitcnt vmcnt(0) lgkmcnt(0)
    v_mfma_f32_16x16x32_bf16 v[16:19], v[188:191], v[144:147], v[16:19]
    v_mfma_f32_16x16x32_bf16 v[20:23], v[188:191], v[148:151], v[20:23]
    v_mfma_f32_16x16x32_bf16 v[24:27], v[188:191], v[152:155], v[24:27]
    v_mfma_f32_16x16x32_bf16 v[28:31], v[188:191], v[156:159], v[28:31]
    v_mfma_f32_16x16x32_bf16 v[32:35], v[192:195], v[144:147], v[32:35]
    v_mfma_f32_16x16x32_bf16 v[36:39], v[192:195], v[148:151], v[36:39]
    v_mfma_f32_16x16x32_bf16 v[40:43], v[192:195], v[152:155], v[40:43]
    s_nop 1
    ds_write_b128 v132, v[16:19] offset:0
    v_mfma_f32_16x16x32_bf16 v[44:47], v[192:195], v[156:159], v[44:47]
    ds_write_b128 v132, v[20:23] offset:16384
    v_mfma_f32_16x16x32_bf16 v[48:51], v[196:199], v[144:147], v[48:51]
    ds_write_b128 v132, v[24:27] offset:32768
    v_mfma_f32_16x16x32_bf16 v[52:55], v[196:199], v[148:151], v[52:55]
    ds_write_b128 v132, v[28:31] offset:49152
    v_mfma_f32_16x16x32_bf16 v[56:59], v[196:199], v[152:155], v[56:59]
    ds_write_b128 v133, v[32:35] offset:0
    v_mfma_f32_16x16x32_bf16 v[60:63], v[196:199], v[156:159], v[60:63]
    ds_write_b128 v133, v[36:39] offset:16384
    v_mfma_f32_16x16x32_bf16 v[64:67], v[200:203], v[144:147], v[64:67]
    ds_write_b128 v133, v[40:43] offset:32768
    v_mfma_f32_16x16x32_bf16 v[68:71], v[200:203], v[148:151], v[68:71]
    ds_write_b128 v133, v[44:47] offset:49152
    v_mfma_f32_16x16x32_bf16 v[72:75], v[200:203], v[152:155], v[72:75]
    ds_write_b128 v134, v[48:51] offset:0
    v_mfma_f32_16x16x32_bf16 v[76:79], v[200:203], v[156:159], v[76:79]
    ds_write_b128 v134, v[52:55] offset:16384
    ds_write_b128 v134, v[56:59] offset:32768
    ds_write_b128 v134, v[60:63] offset:49152
    ds_write_b128 v135, v[64:67] offset:0
    ds_write_b128 v135, v[68:71] offset:16384
    s_nop 0
    ds_write_b128 v135, v[72:75] offset:32768
    s_nop 0
    ds_write_b128 v135, v[76:79] offset:49152
    s_branch k_fbar
k_final:
    s_lshr_b32 s13, s3, 1
    s_and_b32 s58, s3, 1
    s_lshl_b32 s58, s58, 2
    v_and_b32 v2, 15, v1
    v_lshrrev_b32 v3, 4, v1
    v_add_u32 v3, s58, v3
    s_lshl_b32 s59, s13, 14
    v_lshlrev_b32 v5, 1, v3
    v_xor_b32 v5, v5, v2
    v_lshlrev_b32 v5, 4, v5
    v_lshl_add_u32 v5, v2, 8, v5
    v_add_u32 v5, s59, v5
    v_xor_b32 v6, 16, v5
    s_lshl_b32 s13, s13, 4
    v_add_u32 v2, s13, v2
    v_lshlrev_b32 v7, 2, v2
    v_add_u32 v7, 130752, v7
    s_and_b32 s58, s2, 7
    s_lshl_b32 s58, s58, 2
    s_add_u32 s58, s58, s8
    s_lshl_b32 s58, s58, 6
    v_add_u32 v4, s58, v2
    v_mul_u32_u24 v4, 896, v4
    v_lshl_add_u32 v4, v3, 4, v4
    s_lshl_b32 s58, s12, 7
    v_add_u32 v4, s58, v4
    v_bfe_u32 v8, v1, 2, 2
    v_lshl_add_u32 v8, v3, 3, v8
    v_mul_u32_u24 v8, 144, v8
    v_and_b32 v9, 3, v1
    v_lshl_add_u32 v8, v9, 3, v8
    s_lshl_b32 s13, s13, 1
    s_add_u32 s13, s13, 65536
    v_add_u32 v8, s13, v8
k_fbar:
    s_waitcnt lgkmcnt(0)
    s_barrier
k_fw:
    ds_read_b128 v[16:19], v5 offset:0
    ds_read_b128 v[20:23], v6 offset:0
    ds_read_b128 v[24:27], v5 offset:4096
    ds_read_b128 v[28:31], v6 offset:4096
    ds_read_b128 v[32:35], v5 offset:8192
    ds_read_b128 v[36:39], v6 offset:8192
    ds_read_b128 v[40:43], v5 offset:12288
    ds_read_b128 v[44:47], v6 offset:12288
    ds_read_b64_tr_b16 v[48:49], v8
    ds_read_b64_tr_b16 v[50:51], v8 offset:576
    ds_read_b32 v52, v7
    s_waitcnt lgkmcnt(7)
    v_pk_add_f32 v[16:17], v[16:17], v[24:25]
    v_pk_add_f32 v[18:19], v[18:19], v[26:27]
    v_pk_add_f32 v[20:21], v[20:21], v[28:29]
    v_pk_add_f32 v[22:23], v[22:23], v[30:31]
    s_waitcnt lgkmcnt(3)
    v_pk_add_f32 v[32:33], v[32:33], v[40:41]
    v_pk_add_f32 v[34:35], v[34:35], v[42:43]
    v_pk_add_f32 v[36:37], v[36:37], v[44:45]
    v_pk_add_f32 v[38:39], v[38:39], v[46:47]
    v_pk_add_f32 v[16:17], v[16:17], v[32:33]
    v_pk_add_f32 v[18:19], v[18:19], v[34:35]
    v_pk_add_f32 v[20:21], v[20:21], v[36:37]
    v_pk_add_f32 v[22:23], v[22:23], v[38:39]
    s_waitcnt lgkmcnt(0)
    v_lshlrev_b32 v54, 16, v52
    v_and_b32 v55, 0xffff0000, v52
    v_lshlrev_b32 v24, 16, v48
    v_and_b32 v25, 0xffff0000, v48
    v_lshlrev_b32 v26, 16, v49
    v_and_b32 v27, 0xffff0000, v49
    v_lshlrev_b32 v28, 16, v50
    v_and_b32 v29, 0xffff0000, v50
    v_lshlrev_b32 v30, 16, v51
    v_and_b32 v31, 0xffff0000, v51
    v_pk_mul_f32 v[16:17], v[16:17], v[54:55] op_sel:[0,1] op_sel_hi:[1,1]
    v_pk_mul_f32 v[18:19], v[18:19], v[54:55] op_sel:[0,1] op_sel_hi:[1,1]
    v_pk_mul_f32 v[20:21], v[20:21], v[54:55] op_sel:[0,1] op_sel_hi:[1,1]
    v_pk_mul_f32 v[22:23], v[22:23], v[54:55] op_sel:[0,1] op_sel_hi:[1,1]
    v_pk_fma_f32 v[16:17], v[24:25], v[54:55], v[16:17] op_sel_hi:[1,0,1]
    v_pk_fma_f32 v[18:19], v[26:27], v[54:55], v[18:19] op_sel_hi:[1,0,1]
    v_pk_fma_f32 v[20:21], v[28:29], v[54:55], v[20:21] op_sel_hi:[1,0,1]
    v_pk_fma_f32 v[22:23], v[30:31], v[54:55], v[22:23] op_sel_hi:[1,0,1]
    v_cvt_pk_bf16_f32 v32, v16, v17
    v_cvt_pk_bf16_f32 v33, v18, v19
    v_cvt_pk_bf16_f32 v34, v20, v21
    v_cvt_pk_bf16_f32 v35, v22, v23
    global_store_dwordx4 v4, v[32:35], s[96:97] sc0 sc1
k_end:
    s_endpgm
.p2align 6
k_pass:
    ds_read_b64_tr_b16 v[16:17], v4 offset:0
    ds_read_b64_tr_b16 v[18:19], v4 offset:512
    ds_read_b128 v[24:27], v6 offset:0
    ds_read_b128 v[28:31], v6 offset:4096
    ds_read_b64_tr_b16 v[20:21], v5 offset:0
    ds_read_b64_tr_b16 v[22:23], v5 offset:512
    ds_read_b64_tr_b16 v[32:33], v4 offset:2048
    ds_read_b64_tr_b16 v[34:35], v4 offset:2560
    ds_read_b128 v[40:43], v7 offset:0
    ds_read_b128 v[44:47], v7 offset:4096
    ds_read_b64_tr_b16 v[36:37], v5 offset:2048
    ds_read_b64_tr_b16 v[38:39], v5 offset:2560
    s_waitcnt lgkmcnt(6)
    v_mfma_f32_32x32x16_bf16 v[80:95], v[16:19], v[24:27], 0
    ds_read_b64_tr_b16 v[48:49], v4 offset:4096
    ds_read_b64_tr_b16 v[50:51], v4 offset:4608
    ds_read_b128 v[56:59], v8 offset:0
    v_mfma_f32_32x32x16_bf16 v[96:111], v[16:19], v[28:31], 0
    ds_read_b128 v[60:63], v8 offset:4096
    ds_read_b64_tr_b16 v[52:53], v5 offset:4096
    ds_read_b64_tr_b16 v[54:55], v5 offset:4608
    v_mfma_f32_32x32x16_bf16 v[112:127], v[20:23], v[24:27], 0
    ds_read_b64_tr_b16 v[64:65], v4 offset:6144
    ds_read_b64_tr_b16 v[66:67], v4 offset:6656
    ds_read_b128 v[72:75], v9 offset:0
    v_mfma_f32_32x32x16_bf16 v[128:143], v[20:23], v[28:31], 0
    ds_read_b128 v[76:79], v9 offset:4096
    ds_read_b64_tr_b16 v[68:69], v5 offset:6144
    ds_read_b64_tr_b16 v[70:71], v5 offset:6656
    s_waitcnt lgkmcnt(12)
    v_mfma_f32_32x32x16_bf16 v[80:95], v[32:35], v[40:43], v[80:95]
    s_and_b32 s13, s30, 15
    s_lshl_b32 s13, s13, 14
    s_lshr_b32 s30, s30, 4
    s_and_b32 s58, s31, 15
    v_mfma_f32_32x32x16_bf16 v[96:111], v[32:35], v[44:47], v[96:111]
    s_lshl_b32 s58, s58, 14
    s_lshr_b32 s31, s31, 4
    v_add_u32 v6, s13, v2
    v_add_u32 v4, s58, v3
    v_mfma_f32_32x32x16_bf16 v[112:127], v[36:39], v[40:43], v[112:127]
    v_xor_b32 v7, 32, v6
    v_xor_b32 v5, 32, v4
    v_xor_b32 v8, 64, v6
    v_xor_b32 v9, 96, v6
    v_mfma_f32_32x32x16_bf16 v[128:143], v[36:39], v[44:47], v[128:143]
    s_cmp_eq_u32 s43, 0
    s_branch k_pm
.p2align 6
k_pl:
    s_waitcnt lgkmcnt(0)
    v_mfma_f32_32x32x16_bf16 v[80:95], v[16:19], v[24:27], v[80:95]
    ds_read_b64_tr_b16 v[48:49], v4 offset:4096
    ds_read_b64_tr_b16 v[50:51], v4 offset:4608
    ds_read_b128 v[56:59], v8 offset:0
    v_mfma_f32_32x32x16_bf16 v[96:111], v[16:19], v[28:31], v[96:111]
    ds_read_b128 v[60:63], v8 offset:4096
    ds_read_b64_tr_b16 v[52:53], v5 offset:4096
    ds_read_b64_tr_b16 v[54:55], v5 offset:4608
    v_mfma_f32_32x32x16_bf16 v[112:127], v[20:23], v[24:27], v[112:127]
    ds_read_b64_tr_b16 v[64:65], v4 offset:6144
    ds_read_b64_tr_b16 v[66:67], v4 offset:6656
    ds_read_b128 v[72:75], v9 offset:0
    v_mfma_f32_32x32x16_bf16 v[128:143], v[20:23], v[28:31], v[128:143]
    ds_read_b128 v[76:79], v9 offset:4096
    ds_read_b64_tr_b16 v[68:69], v5 offset:6144
    ds_read_b64_tr_b16 v[70:71], v5 offset:6656
    v_mfma_f32_32x32x16_bf16 v[80:95], v[32:35], v[40:43], v[80:95]
    s_and_b32 s13, s30, 15
    s_lshl_b32 s13, s13, 14
    s_lshr_b32 s30, s30, 4
    s_and_b32 s58, s31, 15
    v_mfma_f32_32x32x16_bf16 v[96:111], v[32:35], v[44:47], v[96:111]
    s_lshl_b32 s58, s58, 14
    s_lshr_b32 s31, s31, 4
    v_add_u32 v6, s13, v2
    v_add_u32 v4, s58, v3
    v_mfma_f32_32x32x16_bf16 v[112:127], v[36:39], v[40:43], v[112:127]
    v_xor_b32 v7, 32, v6
    v_xor_b32 v5, 32, v4
    v_xor_b32 v8, 64, v6
    v_xor_b32 v9, 96, v6
    v_mfma_f32_32x32x16_bf16 v[128:143], v[36:39], v[44:47], v[128:143]
    s_cmp_eq_u32 s43, 0
k_pm:
    s_waitcnt lgkmcnt(0)
    v_mfma_f32_32x32x16_bf16 v[80:95], v[48:51], v[56:59], v[80:95]
    s_cbranch_scc1 k_pnb
    s_waitcnt vmcnt(0)
    s_barrier
    s_sub_u32 s43, s43, 1
k_pnb:
    v_mfma_f32_32x32x16_bf16 v[96:111], v[48:51], v[60:63], v[96:111]
    ds_read_b64_tr_b16 v[16:17], v4 offset:0
    ds_read_b64_tr_b16 v[18:19], v4 offset:512
    ds_read_b128 v[24:27], v6 offset:0
    v_mfma_f32_32x32x16_bf16 v[112:127], v[52:55], v[56:59], v[112:127]
    ds_read_b128 v[28:31], v6 offset:4096
    ds_read_b64_tr_b16 v[20:21], v5 offset:0
    ds_read_b64_tr_b16 v[22:23], v5 offset:512
    v_mfma_f32_32x32x16_bf16 v[128:143], v[52:55], v[60:63], v[128:143]
    ds_read_b64_tr_b16 v[32:33], v4 offset:2048
    ds_read_b64_tr_b16 v[34:35], v4 offset:2560
    ds_read_b128 v[40:43], v7 offset:0
    v_mfma_f32_32x32x16_bf16 v[80:95], v[64:67], v[72:75], v[80:95]
    ds_read_b128 v[44:47], v7 offset:4096
    ds_read_b64_tr_b16 v[36:37], v5 offset:2048
    ds_read_b64_tr_b16 v[38:39], v5 offset:2560
    v_mfma_f32_32x32x16_bf16 v[96:111], v[64:67], v[76:79], v[96:111]
    s_sub_u32 s59, s59, 1
    s_cmp_lg_u32 s59, 0
    v_mfma_f32_32x32x16_bf16 v[112:127], v[68:71], v[72:75], v[112:127]
    v_mfma_f32_32x32x16_bf16 v[128:143], v[68:71], v[76:79], v[128:143]
    s_cbranch_scc1 k_pl
    s_setpc_b64 s[100:101]
code_end:
.section .rodata,"a"
.p2align 6
.amdhsa_kernel gated_mix__ssm_conv_s4__swiglu_ffn__prompt_kernel
  .amdhsa_next_free_vgpr 256
  .amdhsa_next_free_sgpr 102
  .amdhsa_accum_offset 256
  .amdhsa_group_segment_fixed_size 0
  .amdhsa_kernarg_size 136
  .amdhsa_user_sgpr_count 2
  .amdhsa_user_sgpr_kernarg_segment_ptr 1
  .amdhsa_system_sgpr_workgroup_id_x 1
.end_amdhsa_kernel
```
